```python
import torch

def _softmax(x, axis=-1):
    return torch.softmax(x, dim=axis)
def _gelu(x):
    return torch.nn.functional.gelu(x, approximate="tanh")
def _silu(x):
    return torch.nn.functional.silu(x)
def _sigmoid(x):
    return torch.sigmoid(x)
def _layernorm(x, axis=-1, eps=1e-5):
    m = x.mean(dim=axis, keepdim=True)
    v = x.var(dim=axis, keepdim=True, unbiased=False)
    return (x - m) / torch.sqrt(v + eps)
def _scatter_add(tgt, idx, src, axis=0):
    return tgt.clone().index_add_(axis, idx, src)
def _segment_sum(src, seg, n):
    out = torch.zeros((n,) + src.shape[1:], dtype=src.dtype)
    return out.index_add_(0, seg, src)
def _pad(x, pw):
    flat = tuple(v for pair in reversed(pw) for v in pair)
    return torch.nn.functional.pad(x, flat)

kernel_name = 'gated_mix__compressed_kv_cla__geglu_ffn__decode'

def setup_inputs():

    _w = (lambda a: (lambda t: t.to(torch.bfloat16) if t.is_floating_point() else t)(torch.as_tensor(a)))
    def _A_setup():
        B, H, Sq, Sk, D, M = 1, 32, 1, 16384, 128, 640
        Dc = 4 * D
        return {
            "x": _w((lambda *s: torch.randn(*s, dtype=torch.bfloat16) * 0.05)(B, Sq, M)),
            "c_kv": _w((lambda *s: torch.randn(*s, dtype=torch.bfloat16) * 0.8)(B, Sk, Dc)),
            "w_q": _w((lambda *s: torch.randn(*s, dtype=torch.bfloat16) * 6.4)(M, H, D) * (M ** -0.5)),
            "w_uk": _w((lambda *s: torch.randn(*s, dtype=torch.bfloat16) * 6.4)(Dc, H, D) * (Dc ** -0.5)),
            "w_uv": _w((lambda *s: torch.randn(*s, dtype=torch.bfloat16) * 0.8)(Dc, H, D) * (Dc ** -0.5)),
            "w_o": _w((lambda *s: torch.randn(*s, dtype=torch.bfloat16) * 0.8)(H, D, M) * ((H * D) ** -0.5)),
        }
    _A_in = _A_setup()

    def _B_setup():
        B, S, D, F = 1, 1, 640, 1728
        return {
            "x": _w((lambda *s: torch.randn(*s, dtype=torch.bfloat16) * 0.05)(B, S, D)),
            "w_gate": _w((lambda *s: torch.randn(*s, dtype=torch.bfloat16) * 0.1)(D, F)),
            "w_up": _w((lambda *s: torch.randn(*s, dtype=torch.bfloat16) * 0.1)(D, F)),
            "w_down": _w((lambda *s: torch.randn(*s, dtype=torch.bfloat16) * 0.1)(F, D)),
        }
    _B_in = _B_setup()

    return {
        "A_x": _A_in["x"],
        "A_c_kv": _A_in["c_kv"],
        "A_w_q": _A_in["w_q"],
        "A_w_uk": _A_in["w_uk"],
        "A_w_uv": _A_in["w_uv"],
        "A_w_o": _A_in["w_o"],
        "B_x": _B_in["x"],
        "B_w_gate": _B_in["w_gate"],
        "B_w_up": _B_in["w_up"],
        "B_w_down": _B_in["w_down"],
        "gate_w": _w((lambda *s: torch.randn(*s, dtype=torch.bfloat16) * 0.1)(640) * 16.0),
    }

def reference(A_x, A_c_kv, A_w_q, A_w_uk, A_w_uv, A_w_o, B_x, B_w_gate, B_w_up, B_w_down, gate_w):
    def _A_ref(x, c_kv, w_q, w_uk, w_uv, w_o):
        B, Sq, M = x.shape[0], x.shape[1], x.shape[2]
        Sk = c_kv.shape[1]
        H, D = w_q.shape[1], w_q.shape[2]
        q = torch.einsum("bqm,mhd->bhqd", x, w_q)
        k = torch.einsum("bkc,chd->bhkd", c_kv, w_uk)
        v = torch.einsum("bkc,chd->bhkd", c_kv, w_uv)
        scores = torch.einsum("bhqd,bhkd->bhqk", q, k) * (D ** -0.5)
        off = Sk - Sq
        qi = torch.arange(Sq)[:, None]
        kj = torch.arange(Sk)[None, :]
        cmask = kj <= (qi + off)
        scores = torch.where(cmask[None, None], scores, -1e9)
        p = _softmax(scores, axis=-1)
        ctx = torch.einsum("bhqk,bhkd->bhqd", p, v)
        return torch.einsum("bhqd,hdm->bqm", ctx, w_o)

    def _B_ref(x, w_gate, w_up, w_down):
        return (_gelu(x @ w_gate) * (x @ w_up)) @ w_down

    x = A_x
    g = _sigmoid((x * gate_w).sum(-1, keepdims=True))
    a = _A_ref(x, A_c_kv, A_w_q, A_w_uk, A_w_uv, A_w_o)
    b = _B_ref(x, B_w_gate, B_w_up, B_w_down)
    return g * a + (1 - g) * b
```

```asm
; @launch grid=(256,1,1) block=(256,1,1) lds=163840
.amdgcn_target "amdgcn-amd-amdhsa--gfx950"
.text
.globl gated_mix__compressed_kv_cla__geglu_ffn__decode_kernel
.p2align 8
.type gated_mix__compressed_kv_cla__geglu_ffn__decode_kernel,@function
gated_mix__compressed_kv_cla__geglu_ffn__decode_kernel:
    v_lshrrev_b32 v1, 6, v0
    s_cmp_ge_u32 s2, 256
    s_cbranch_scc1 L_end
    v_readfirstlane_b32 s3, v1
    v_and_b32 v0, 63, v0
    s_cmp_ge_u32 s2, 128
    s_cbranch_scc1 L_wgt
L_att:
    s_load_dwordx2 s[12:13], s[0:1], 16
    s_load_dwordx2 s[24:25], s[0:1], 24
    s_load_dwordx2 s[8:9], s[0:1], 8
    s_load_dwordx2 s[20:21], s[0:1], 104
    s_load_dwordx2 s[16:17], s[0:1], 88
    s_load_dwordx2 s[28:29], s[0:1], 32
    s_mov_b32 s14, 5242880
    s_mov_b32 s15, 0x20000
    s_mov_b32 s26, 4194304
    s_mov_b32 s27, 0x20000
    s_mov_b32 s10, 16777216
    s_mov_b32 s11, 0x20000
    s_mov_b32 s22, 7340032
    s_mov_b32 s23, 0x20000
    s_mov_b32 s18, 1280
    s_mov_b32 s19, 0x20000
    s_mov_b32 s30, 4194304
    s_mov_b32 s31, 0x20000
    s_and_b32 s44, s2, 7
    s_lshr_b32 s45, s2, 3
    s_getpc_b64 s[38:39]
L_pc:
    s_sub_u32 s38, s38, L_pc-gated_mix__compressed_kv_cla__geglu_ffn__decode_kernel
    s_subb_u32 s39, s39, 0
    s_lshl_b32 s49, s45, 2
    s_add_u32 s49, s49, s3
    s_lshl_b32 s49, s49, 7
    v_lshlrev_b32 v3, 13, v0
    v_add_u32 v3, s49, v3
    v_cmp_gt_u32 vcc, L_end-gated_mix__compressed_kv_cla__geglu_ffn__decode_kernel, v3
    s_nop 0
    s_and_saveexec_b64 s[32:33], vcc
    global_load_dword v213, v3, s[38:39]
    s_mov_b64 exec, -1
    s_lshr_b32 s49, s45, 2
    s_lshl_b32 s46, s44, 2
    s_add_u32 s46, s46, s49
    s_and_b32 s47, s45, 3
    v_lshrrev_b32 v3, 3, v0
    v_lshlrev_b32 v2, 13, v3
    v_and_b32 v3, 7, v0
    v_lshl_add_u32 v2, v3, 7, v2
    v_bfe_u32 v3, v0, 2, 2
    v_mul_u32_u24 v1, 40, v3
    v_bfe_u32 v3, v0, 1, 1
    v_add_u32 v1, v1, v3
    v_lshrrev_b32 v3, 4, v0
    v_lshl_add_u32 v1, v3, 1, v1
    v_lshlrev_b32 v1, 13, v1
    v_and_b32 v3, 1, v0
    v_lshl_add_u32 v1, v3, 7, v1
    s_mul_i32 s51, s47, 160
    s_mul_i32 s49, s3, 10
    s_add_u32 s51, s51, s49
    s_add_u32 s51, s51, 6
    s_lshl_b32 s51, s51, 13
    s_lshl_b32 s49, s46, 8
    s_add_u32 s51, s51, s49
    s_lshl_b32 s49, s44, 10
    s_lshl_b32 s50, s44, 4
    s_add_u32 s50, s50, s45
    s_lshl_b32 s52, s45, 2
    s_add_u32 s52, s52, s3
    s_lshl_b32 s52, s52, 16
    s_add_u32 s52, s52, s49
    v_lshrrev_b32 v3, 3, v0
    v_and_b32 v4, 6, v3
    v_and_b32 v5, 7, v0
    v_xor_b32 v4, v4, v5
    v_lshlrev_b32 v4, 4, v4
    v_lshl_add_u32 v14, v3, 10, v4
    v_xor_b32 v15, 16, v14
    s_lshl_b32 s53, s50, 17
    s_lshl_b32 s54, s3, 15
    s_add_u32 s53, s53, s54
    s_mul_i32 s49, s3, 256
    s_add_u32 s53, s53, s49
    s_waitcnt lgkmcnt(0)
    s_mov_b32 exec_hi, 0
    s_mov_b32 exec_lo, -1
    buffer_load_dword v8, v1, s[12:15], s51 offen
    s_mov_b64 exec, -1
    s_load_dword s40, s[20:21], 0
    v_lshlrev_b32 v7, 4, v0
    v_and_b32 v220, 15, v0
    v_mov_b32 v214, 0xff
    v_mov_b32 v215, 0x10001
    v_mov_b32 v11, 0
    v_and_b32 v3, 6, v0
    v_bfe_u32 v4, v0, 3, 1
    v_or_b32 v3, v3, v4
    v_lshrrev_b32 v4, 5, v0
    v_xor_b32 v3, v3, v4
    v_lshlrev_b32 v3, 4, v3
    v_and_b32 v5, 7, v0
    v_lshl_add_u32 v3, v5, 7, v3
    v_bfe_u32 v5, v0, 3, 2
    v_lshl_add_u32 v3, v5, 13, v3
    v_add_u32 v36, s54, v3
    s_lshl_b32 s49, s3, 13
    s_add_u32 s34, s49, 131072
    s_add_u32 s35, s49, 131072
    v_xor_b32 v37, 32, v36
    v_xor_b32 v38, 64, v36
    v_xor_b32 v39, 96, v36
    v_xor_b32 v3, v220, v4
    v_lshlrev_b32 v3, 4, v3
    v_and_b32 v5, 31, v0
    v_lshl_add_u32 v3, v5, 10, v3
    s_mul_i32 s49, s3, 256
    s_add_u32 s49, s49, 131072
    v_add_u32 v240, s49, v3
    s_and_b32 s49, s3, 1
    s_lshl_b32 s49, s49, 7
    v_xor_b32 v248, s49, v7
    v_add_u32 v248, s35, v248
    v_xor_b32 v241, 32, v240
    v_xor_b32 v249, 16, v248
    v_xor_b32 v242, 64, v240
    v_xor_b32 v250, 32, v248
    v_xor_b32 v243, 96, v240
    v_xor_b32 v251, 48, v248
    v_xor_b32 v244, 128, v240
    v_xor_b32 v252, 64, v248
    v_xor_b32 v245, 160, v240
    v_xor_b32 v253, 80, v248
    v_xor_b32 v246, 192, v240
    v_xor_b32 v254, 96, v248
    v_xor_b32 v247, 224, v240
    v_xor_b32 v255, 112, v248
    v_bfe_u32 v3, v0, 2, 3
    v_and_b32 v4, 6, v3
    v_bfe_u32 v5, v0, 1, 1
    v_xor_b32 v4, v4, v5
    v_lshlrev_b32 v4, 4, v4
    v_lshl_add_u32 v4, v3, 7, v4
    v_and_b32 v5, 1, v0
    v_lshl_add_u32 v4, v5, 3, v4
    v_lshrrev_b32 v5, 5, v0
    v_lshl_add_u32 v4, v5, 14, v4
    s_lshl_b32 s49, s3, 5
    v_xor_b32 v192, s49, v4
    v_xor_b32 v193, 16, v192
    v_add_u32 v193, 8192, v193
    v_add_u32 v194, 0x10000, v192
    v_add_u32 v195, 0x10000, v193
    v_lshlrev_b32 v4, 7, v3
    v_lshrrev_b32 v3, 1, v3
    v_lshl_add_u32 v4, v3, 5, v4
    v_and_b32 v3, 3, v0
    v_lshl_add_u32 v4, v3, 3, v4
    v_lshl_add_u32 v4, v5, 13, v4
    v_add_u32 v44, s54, v4
    v_xor_b32 v45, 32, v44
    v_xor_b32 v46, 64, v44
    v_xor_b32 v47, 96, v44
    v_bfe_u32 v3, v0, 3, 1
    v_lshlrev_b32 v3, 6, v3
    v_lshl_add_u32 v3, v5, 2, v3
    v_bfe_u32 v4, v0, 4, 1
    v_add_u32 v3, v3, v4
    v_lshlrev_b32 v10, 13, v3
    v_lshrrev_b32 v3, 4, v0
    v_bfe_u32 v4, v0, 1, 2
    v_xor_b32 v3, v3, v4
    v_lshl_add_u32 v10, v3, 5, v10
    v_and_b32 v3, 1, v0
    v_lshl_add_u32 v10, v3, 4, v10
    v_lshlrev_b32 v3, 4, v3
    v_mov_b32 v4, 0xffff
    v_lshlrev_b32 v3, v3, v4
    v_bfe_u32 v4, v0, 1, 3
    v_cmp_eq_u32 vcc, 0, v4
    v_mov_b32 v204, 0
    s_nop 0
    v_cndmask_b32 v16, 0, v3, vcc
    v_cmp_eq_u32 vcc, 1, v4
    v_mov_b32 v205, 0
    s_nop 0
    v_cndmask_b32 v17, 0, v3, vcc
    v_cmp_eq_u32 vcc, 2, v4
    v_mov_b32 v206, 0
    s_nop 0
    v_cndmask_b32 v18, 0, v3, vcc
    v_cmp_eq_u32 vcc, 3, v4
    v_mov_b32 v207, 0
    s_nop 0
    v_cndmask_b32 v19, 0, v3, vcc
    v_and_b32 v3, 31, v0
    v_lshlrev_b32 v223, 5, v3
    v_add_u32 v223, 131072, v223
    v_lshrrev_b32 v4, 5, v0
    v_lshl_add_u32 v222, v4, 2, v223
    s_lshl_b32 s49, s3, 3
    v_add_u32 v222, s49, v222
    s_add_u32 s49, s49, 144384
    v_bfe_u32 v5, v0, 1, 2
    v_lshlrev_b32 v231, 4, v5
    v_lshlrev_b32 v5, 5, v5
    v_add_u32 v210, s49, v5
    v_lshlrev_b32 v226, 4, v220
    v_lshl_add_u32 v226, v4, 8, v226
    v_bfe_u32 v4, v0, 4, 1
    v_lshl_add_u32 v226, v4, 10, v226
    s_lshl_b32 s49, s3, 11
    s_add_u32 s49, s49, 133120
    v_add_u32 v226, s49, v226
    v_add_u32 v227, 133120, v7
    v_lshlrev_b32 v228, 4, v3
    v_lshlrev_b32 v212, 3, v3
    v_lshrrev_b32 v4, 4, v0
    v_lshlrev_b32 v229, 4, v220
    v_lshl_add_u32 v230, v4, 15, v229
    v_lshl_add_u32 v229, v4, 12, v229
    v_lshlrev_b32 v208, 2, v220
    v_lshl_add_u32 v208, v4, 9, v208
    s_lshl_b32 s49, s3, 6
    s_add_u32 s49, s49, 143360
    v_add_u32 v208, s49, v208
    v_bfe_u32 v3, v0, 3, 1
    v_and_b32 v5, 1, v0
    v_lshl_add_u32 v3, v3, 1, v5
    v_lshl_add_u32 v3, v3, 2, v4
    v_lshl_add_u32 v231, v3, 9, v231
    v_and_b32 v3, 3, v0
    v_lshlrev_b32 v3, 6, v3
    v_lshl_add_u32 v3, v4, 4, v3
    s_lshl_b32 s49, s3, 8
    s_add_u32 s49, s49, 143360
    v_add_u32 v3, s49, v3
    v_mov_b32 v209, 142336
    s_lshl_b32 s49, s3, 5
    s_add_u32 s49, s49, 144384
    v_mov_b32 v211, s49
    v_lshrrev_b32 v6, 1, v220
    v_lshlrev_b32 v6, 8, v6
    v_lshl_add_u32 v6, v4, 11, v6
    v_lshl_add_u32 v6, v5, 3, v6
    v_bfe_u32 v4, v0, 2, 2
    v_cmp_eq_u32 vcc, 0, v4
    s_nop 1
    v_cndmask_b32 v200, v209, v3, vcc
    v_cmp_eq_u32 vcc, 1, v4
    s_nop 1
    v_cndmask_b32 v201, v209, v3, vcc
    v_cmp_eq_u32 vcc, 2, v4
    s_nop 1
    v_cndmask_b32 v202, v209, v3, vcc
    v_cmp_eq_u32 vcc, 3, v4
    s_nop 1
    v_cndmask_b32 v203, v209, v3, vcc
    s_lshl_b32 s58, s3, 20
    s_lshl_b32 s49, s50, 8
    s_add_u32 s58, s58, s49
    s_add_u32 s58, s58, 2097152
    s_lshl_b32 s4, s50, 15
    s_lshl_b32 s49, s3, 10
    s_add_u32 s4, s4, s49
    s_add_u32 s4, s4, 2097152
    s_add_u32 s5, s4, 16384
    s_lshl_b32 s59, s3, 14
    s_lshl_b32 s49, s44, 6
    s_add_u32 s59, s59, s49
    s_add_u32 s59, s59, 196608
    s_add_u32 s36, s59, 8192
    s_lshl_b32 s6, s44, 2
    s_add_u32 s6, s6, s3
    s_lshl_b32 s60, s6, 8
    s_lshl_b32 s6, s6, 13
    s_lshl_b32 s49, s45, 4
    s_add_u32 s6, s6, s49
    s_add_u32 s6, s6, 1048576
    s_lshl_b32 s49, s47, 20
    s_add_u32 s60, s60, s49
    s_lshr_b32 s49, s45, 2
    s_lshl_b32 s49, s49, 17
    s_add_u32 s60, s60, s49
    s_lshl_b32 s7, s44, 8
    s_add_u32 s7, s7, 4096
    s_lshl_b32 s49, s3, 3
    s_lshl_b32 s62, 0xff, s49
    s_mov_b32 s63, 0
    s_lshl_b32 s32, s50, 9
    s_add_u32 s32, s32, 196608
    s_mov_b32 s37, 0x3e0293ee
    s_waitcnt lgkmcnt(0)
    s_add_u32 s40, s40, 0x01010101
    s_lshr_b32 s41, s40, 8
    s_lshr_b32 s42, s40, 16
    s_lshr_b32 s43, s40, 24
    v_mov_b32 v234, s40
    v_mov_b32 v235, s40
    v_lshlrev_b32 v3, 4, v5
    v_lshrrev_b32 v12, v3, v234
    v_lshrrev_b32 v13, 8, v12
    v_and_b32 v3, 3, v0
    v_lshlrev_b32 v3, 3, v3
    v_lshrrev_b32 v3, v3, v234
    v_bfe_i32 v5, v0, 4, 1
    s_bfe_i32 s49, s50, 0x10000
    v_bfe_u32 v4, v3, 0, 2
    v_lshl_or_b32 v196, v4, 15, v4
    v_xor_b32 v20, s49, v196
    v_xor_b32 v40, v5, v196
    v_bfe_u32 v4, v3, 2, 2
    v_lshl_or_b32 v197, v4, 15, v4
    v_xor_b32 v21, s49, v197
    v_xor_b32 v41, v5, v197
    v_bfe_u32 v4, v3, 4, 2
    v_lshl_or_b32 v198, v4, 15, v4
    v_xor_b32 v22, s49, v198
    v_xor_b32 v42, v5, v198
    v_bfe_u32 v4, v3, 6, 2
    v_lshl_or_b32 v199, v4, 15, v4
    v_xor_b32 v23, s49, v199
    v_xor_b32 v43, v5, v199
    s_waitcnt vmcnt(0)
    buffer_load_dword v9, v2, s[24:27], s52 offen
    s_getreg_b32 s56, hwreg(HW_REG_XCC_ID, 0, 4)
    s_cmp_lg_u32 s3, 1
    s_cbranch_scc1 L_xc_1
    v_mov_b32 v4, s56
    v_mov_b32 v5, s40
    v_mov_b32 v3, 0
    s_lshl_b32 s49, s44, 8
    s_and_b32 m0, s2, 0xf8
    s_add_u32 s49, s49, m0
    s_add_u32 s49, s49, 4096
    s_mov_b64 exec, 1
    buffer_store_dwordx2 v[4:5], v3, s[20:23], s49 offen sc1
    s_mov_b64 exec, -1
L_xc_1:
    s_add_u32 m0, s54, 0
    s_xor_b32 s49, s53, 0
    buffer_load_dwordx4 v14, s[8:11], s49 offen nt lds
    s_add_u32 m0, s54, 8192
    s_xor_b32 s49, s53, 8192
    buffer_load_dwordx4 v15, s[8:11], s49 offen nt lds
    s_add_u32 m0, s54, 16384
    s_xor_b32 s49, s53, 16384
    buffer_load_dwordx4 v14, s[8:11], s49 offen nt lds
    s_add_u32 m0, s54, 24576
    s_xor_b32 s49, s53, 24576
    buffer_load_dwordx4 v15, s[8:11], s49 offen nt lds
    s_add_u32 m0, s54, 1024
    s_xor_b32 s49, s53, 128
    buffer_load_dwordx4 v14, s[8:11], s49 offen nt lds
    s_add_u32 m0, s54, 9216
    s_xor_b32 s49, s53, 8320
    buffer_load_dwordx4 v15, s[8:11], s49 offen nt lds
    s_add_u32 m0, s54, 17408
    s_xor_b32 s49, s53, 16512
    buffer_load_dwordx4 v14, s[8:11], s49 offen nt lds
    s_add_u32 m0, s54, 25600
    s_xor_b32 s49, s53, 24704
    buffer_load_dwordx4 v15, s[8:11], s49 offen nt lds
    s_add_u32 m0, s54, 2048
    s_xor_b32 s49, s53, 256
    buffer_load_dwordx4 v14, s[8:11], s49 offen nt lds
    s_add_u32 m0, s54, 10240
    s_xor_b32 s49, s53, 8448
    buffer_load_dwordx4 v15, s[8:11], s49 offen nt lds
    s_add_u32 m0, s54, 18432
    s_xor_b32 s49, s53, 16640
    buffer_load_dwordx4 v14, s[8:11], s49 offen nt lds
    s_add_u32 m0, s54, 26624
    s_xor_b32 s49, s53, 24832
    buffer_load_dwordx4 v15, s[8:11], s49 offen nt lds
    s_waitcnt vmcnt(8)
    ds_read_b128 a[0:3], v36 offset:0
    ds_read_b128 a[4:7], v37 offset:0
    ds_read_b128 a[8:11], v38 offset:0
    ds_read_b128 a[12:15], v39 offset:0
    s_barrier
    ds_read_b64_tr_b16 a[128:129], v192 offset:0
    ds_read_b64_tr_b16 a[130:131], v193 offset:0
    ds_read_b64_tr_b16 a[164:165], v192 offset:32768
    ds_read_b64_tr_b16 a[166:167], v193 offset:32768
    ds_read_b64_tr_b16 a[200:201], v194 offset:0
    ds_read_b64_tr_b16 a[202:203], v195 offset:0
    ds_read_b64_tr_b16 a[236:237], v194 offset:32768
    ds_read_b64_tr_b16 a[238:239], v195 offset:32768
    s_add_u32 m0, s54, 3072
    s_xor_b32 s49, s53, 384
    buffer_load_dwordx4 v14, s[8:11], s49 offen nt lds
    s_add_u32 m0, s54, 11264
    s_xor_b32 s49, s53, 8576
    buffer_load_dwordx4 v15, s[8:11], s49 offen nt lds
    s_add_u32 m0, s54, 19456
    s_xor_b32 s49, s53, 16768
    buffer_load_dwordx4 v14, s[8:11], s49 offen nt lds
    s_add_u32 m0, s54, 27648
    s_xor_b32 s49, s53, 24960
    buffer_load_dwordx4 v15, s[8:11], s49 offen nt lds
    s_waitcnt vmcnt(8)
    ds_read_b128 a[16:19], v36 offset:1024
    ds_read_b128 a[20:23], v37 offset:1024
    ds_read_b128 a[24:27], v38 offset:1024
    ds_read_b128 a[28:31], v39 offset:1024
    s_barrier
    ds_read_b64_tr_b16 a[144:145], v192 offset:1024
    ds_read_b64_tr_b16 a[146:147], v193 offset:1024
    ds_read_b64_tr_b16 a[180:181], v192 offset:33792
    ds_read_b64_tr_b16 a[182:183], v193 offset:33792
    ds_read_b64_tr_b16 a[216:217], v194 offset:1024
    ds_read_b64_tr_b16 a[218:219], v195 offset:1024
    ds_read_b64_tr_b16 a[252:253], v194 offset:33792
    ds_read_b64_tr_b16 a[254:255], v195 offset:33792
    s_waitcnt vmcnt(4)
    ds_read_b128 a[32:35], v36 offset:2048
    ds_read_b128 a[36:39], v37 offset:2048
    ds_read_b128 a[40:43], v38 offset:2048
    ds_read_b128 a[44:47], v39 offset:2048
    s_barrier
    ds_read_b64_tr_b16 a[160:161], v192 offset:2048
    ds_read_b64_tr_b16 a[162:163], v193 offset:2048
    ds_read_b64_tr_b16 a[132:133], v192 offset:34816
    ds_read_b64_tr_b16 a[134:135], v193 offset:34816
    ds_read_b64_tr_b16 a[232:233], v194 offset:2048
    ds_read_b64_tr_b16 a[234:235], v195 offset:2048
    ds_read_b64_tr_b16 a[204:205], v194 offset:34816
    ds_read_b64_tr_b16 a[206:207], v195 offset:34816
    s_waitcnt vmcnt(0)
    ds_read_b128 a[48:51], v36 offset:3072
    ds_read_b128 a[52:55], v37 offset:3072
    ds_read_b128 a[56:59], v38 offset:3072
    ds_read_b128 a[60:63], v39 offset:3072
    s_barrier
    ds_read_b64_tr_b16 a[176:177], v192 offset:3072
    ds_read_b64_tr_b16 a[178:179], v193 offset:3072
    ds_read_b64_tr_b16 a[148:149], v192 offset:35840
    ds_read_b64_tr_b16 a[150:151], v193 offset:35840
    ds_read_b64_tr_b16 a[248:249], v194 offset:3072
    ds_read_b64_tr_b16 a[250:251], v195 offset:3072
    ds_read_b64_tr_b16 a[220:221], v194 offset:35840
    ds_read_b64_tr_b16 a[222:223], v195 offset:35840
    buffer_load_dwordx4 v[64:67], v7, s[20:23], s34 offen offset:0 sc1
    buffer_load_dwordx4 v[68:71], v7, s[20:23], s34 offen offset:1024 sc1
    buffer_load_dwordx4 v[72:75], v7, s[20:23], s34 offen offset:2048 sc1
    buffer_load_dwordx4 v[76:79], v7, s[20:23], s34 offen offset:3072 sc1
    s_add_u32 s49, s34, 4096
    buffer_load_dwordx4 v[80:83], v7, s[20:23], s49 offen offset:0 sc1
    buffer_load_dwordx4 v[84:87], v7, s[20:23], s49 offen offset:1024 sc1
    buffer_load_dwordx4 v[88:91], v7, s[20:23], s49 offen offset:2048 sc1
    buffer_load_dwordx4 v[92:95], v7, s[20:23], s49 offen offset:3072 sc1
    s_mov_b32 s48, 0
    s_waitcnt vmcnt(7)
    ds_write_b128 v248, v[64:67] offset:0
    v_xor_b32 v2, v64, v196
    v_bitop3_b32 v2, v2, v65, v197 bitop3:0xf6
    v_bitop3_b32 v2, v2, v66, v198 bitop3:0xf6
    v_bitop3_b32 v2, v2, v67, v199 bitop3:0xf6
    s_add_u32 m0, s54, 4096
    s_xor_b32 s49, s53, 512
    buffer_load_dwordx4 v14, s[8:11], s49 offen nt lds
    s_waitcnt vmcnt(7)
    ds_write_b128 v249, v[68:71] offset:1024
    v_bitop3_b32 v2, v2, v68, v196 bitop3:0xf6
    v_bitop3_b32 v2, v2, v69, v197 bitop3:0xf6
    v_bitop3_b32 v2, v2, v70, v198 bitop3:0xf6
    v_bitop3_b32 v2, v2, v71, v199 bitop3:0xf6
    s_add_u32 m0, s54, 12288
    s_xor_b32 s49, s53, 8704
    buffer_load_dwordx4 v15, s[8:11], s49 offen nt lds
    s_waitcnt vmcnt(7)
    ds_write_b128 v250, v[72:75] offset:2048
    v_bitop3_b32 v2, v2, v72, v196 bitop3:0xf6
    v_bitop3_b32 v2, v2, v73, v197 bitop3:0xf6
    v_bitop3_b32 v2, v2, v74, v198 bitop3:0xf6
    v_bitop3_b32 v2, v2, v75, v199 bitop3:0xf6
    s_add_u32 m0, s54, 20480
    s_xor_b32 s49, s53, 16896
    buffer_load_dwordx4 v14, s[8:11], s49 offen nt lds
    s_waitcnt vmcnt(7)
    ds_write_b128 v251, v[76:79] offset:3072
    v_bitop3_b32 v2, v2, v76, v196 bitop3:0xf6
    v_bitop3_b32 v2, v2, v77, v197 bitop3:0xf6
    v_bitop3_b32 v2, v2, v78, v198 bitop3:0xf6
    v_bitop3_b32 v2, v2, v79, v199 bitop3:0xf6
    s_add_u32 m0, s54, 28672
    s_xor_b32 s49, s53, 25088
    buffer_load_dwordx4 v15, s[8:11], s49 offen nt lds
    s_waitcnt vmcnt(7)
    ds_write_b128 v252, v[80:83] offset:4096
    v_bitop3_b32 v2, v2, v80, v196 bitop3:0xf6
    v_bitop3_b32 v2, v2, v81, v197 bitop3:0xf6
    v_bitop3_b32 v2, v2, v82, v198 bitop3:0xf6
    v_bitop3_b32 v2, v2, v83, v199 bitop3:0xf6
    s_add_u32 m0, s54, 5120
    s_xor_b32 s49, s53, 640
    buffer_load_dwordx4 v14, s[8:11], s49 offen nt lds
    s_waitcnt vmcnt(7)
    ds_write_b128 v253, v[84:87] offset:5120
    v_bitop3_b32 v2, v2, v84, v196 bitop3:0xf6
    v_bitop3_b32 v2, v2, v85, v197 bitop3:0xf6
    v_bitop3_b32 v2, v2, v86, v198 bitop3:0xf6
    v_bitop3_b32 v2, v2, v87, v199 bitop3:0xf6
    s_add_u32 m0, s54, 13312
    s_xor_b32 s49, s53, 8832
    buffer_load_dwordx4 v15, s[8:11], s49 offen nt lds
    s_waitcnt vmcnt(7)
    ds_write_b128 v254, v[88:91] offset:6144
    v_bitop3_b32 v2, v2, v88, v196 bitop3:0xf6
    v_bitop3_b32 v2, v2, v89, v197 bitop3:0xf6
    v_bitop3_b32 v2, v2, v90, v198 bitop3:0xf6
    v_bitop3_b32 v2, v2, v91, v199 bitop3:0xf6
    s_add_u32 m0, s54, 21504
    s_xor_b32 s49, s53, 17024
    buffer_load_dwordx4 v14, s[8:11], s49 offen nt lds
    s_waitcnt vmcnt(7)
    ds_write_b128 v255, v[92:95] offset:7168
    v_bitop3_b32 v2, v2, v92, v196 bitop3:0xf6
    v_bitop3_b32 v2, v2, v93, v197 bitop3:0xf6
    v_bitop3_b32 v2, v2, v94, v198 bitop3:0xf6
    v_bitop3_b32 v2, v2, v95, v199 bitop3:0xf6
    s_add_u32 m0, s54, 29696
    s_xor_b32 s49, s53, 25216
    buffer_load_dwordx4 v15, s[8:11], s49 offen nt lds
    v_and_b32 v2, 0x10001, v2
    v_cmp_ne_u32 vcc, 0, v2
    s_waitcnt lgkmcnt(0)
    s_cbranch_vccnz L_qr_3
L_q_2:
    s_barrier
    ds_read_b128 v[128:131], v240
    v_xor_b32 v240, 256, v240
    ds_read_b128 v[132:135], v241
    v_xor_b32 v241, 256, v241
    ds_read_b128 v[136:139], v242
    v_xor_b32 v242, 256, v242
    ds_read_b128 v[140:143], v243
    v_xor_b32 v243, 256, v243
    s_waitcnt lgkmcnt(3)
    v_mfma_f32_32x32x16_bf16 v[48:63], a[0:3], v[128:131], 0
    ds_read_b128 v[144:147], v244
    v_xor_b32 v244, 256, v244
    s_add_u32 m0, s54, 6144
    s_xor_b32 s49, s53, 768
    buffer_load_dwordx4 v14, s[8:11], s49 offen nt lds
    s_waitcnt lgkmcnt(3)
    v_mfma_f32_32x32x16_bf16 v[48:63], a[4:7], v[132:135], v[48:63]
    ds_read_b128 v[148:151], v245
    v_xor_b32 v245, 256, v245
    s_add_u32 m0, s54, 14336
    s_xor_b32 s49, s53, 8960
    buffer_load_dwordx4 v15, s[8:11], s49 offen nt lds
    s_waitcnt lgkmcnt(3)
    v_mfma_f32_32x32x16_bf16 v[48:63], a[8:11], v[136:139], v[48:63]
    ds_read_b128 v[152:155], v246
    v_xor_b32 v246, 256, v246
    s_add_u32 m0, s54, 22528
    s_xor_b32 s49, s53, 17152
    buffer_load_dwordx4 v14, s[8:11], s49 offen nt lds
    s_waitcnt lgkmcnt(3)
    v_mfma_f32_32x32x16_bf16 v[48:63], a[12:15], v[140:143], v[48:63]
    ds_read_b128 v[156:159], v247
    v_xor_b32 v247, 256, v247
    s_add_u32 m0, s54, 30720
    s_xor_b32 s49, s53, 25344
    buffer_load_dwordx4 v15, s[8:11], s49 offen nt lds
    s_waitcnt lgkmcnt(3)
    v_mfma_f32_32x32x16_bf16 v[48:63], a[16:19], v[144:147], v[48:63]
    ds_read_b128 v[160:163], v240
    v_xor_b32 v240, 768, v240
    s_add_u32 m0, s54, 7168
    s_xor_b32 s49, s53, 896
    buffer_load_dwordx4 v14, s[8:11], s49 offen nt lds
    s_waitcnt lgkmcnt(3)
    v_mfma_f32_32x32x16_bf16 v[48:63], a[20:23], v[148:151], v[48:63]
    ds_read_b128 v[164:167], v241
    v_xor_b32 v241, 768, v241
    s_add_u32 m0, s54, 15360
    s_xor_b32 s49, s53, 9088
    buffer_load_dwordx4 v15, s[8:11], s49 offen nt lds
    s_waitcnt lgkmcnt(3)
    v_mfma_f32_32x32x16_bf16 v[48:63], a[24:27], v[152:155], v[48:63]
    ds_read_b128 v[168:171], v242
    v_xor_b32 v242, 768, v242
    s_add_u32 m0, s54, 23552
    s_xor_b32 s49, s53, 17280
    buffer_load_dwordx4 v14, s[8:11], s49 offen nt lds
    s_waitcnt lgkmcnt(3)
    v_mfma_f32_32x32x16_bf16 v[48:63], a[28:31], v[156:159], v[48:63]
    ds_read_b128 v[172:175], v243
    v_xor_b32 v243, 768, v243
    s_add_u32 m0, s54, 31744
    s_xor_b32 s49, s53, 25472
    buffer_load_dwordx4 v15, s[8:11], s49 offen nt lds
    s_waitcnt lgkmcnt(3)
    v_mfma_f32_32x32x16_bf16 v[48:63], a[32:35], v[160:163], v[48:63]
    ds_read_b128 v[176:179], v244
    v_xor_b32 v244, 768, v244
    s_waitcnt lgkmcnt(3)
    v_mfma_f32_32x32x16_bf16 v[48:63], a[36:39], v[164:167], v[48:63]
    ds_read_b128 v[180:183], v245
    v_xor_b32 v245, 768, v245
    s_waitcnt lgkmcnt(3)
    v_mfma_f32_32x32x16_bf16 v[48:63], a[40:43], v[168:171], v[48:63]
    ds_read_b128 v[184:187], v246
    v_xor_b32 v246, 768, v246
    s_waitcnt lgkmcnt(3)
    v_mfma_f32_32x32x16_bf16 v[48:63], a[44:47], v[172:175], v[48:63]
    ds_read_b128 v[188:191], v247
    v_xor_b32 v247, 768, v247
    s_waitcnt vmcnt(12)
    ds_read_b128 a[64:67], v36 offset:4096
    ds_read_b128 a[68:71], v37 offset:4096
    ds_read_b128 a[72:75], v38 offset:4096
    ds_read_b128 a[76:79], v39 offset:4096
    s_waitcnt lgkmcnt(7)
    v_mfma_f32_32x32x16_bf16 v[48:63], a[48:51], v[176:179], v[48:63]
    ds_read_b128 v[128:131], v240
    v_xor_b32 v240, 256, v240
    s_waitcnt lgkmcnt(7)
    v_mfma_f32_32x32x16_bf16 v[48:63], a[52:55], v[180:183], v[48:63]
    ds_read_b128 v[132:135], v241
    v_xor_b32 v241, 256, v241
    s_waitcnt lgkmcnt(7)
    v_mfma_f32_32x32x16_bf16 v[48:63], a[56:59], v[184:187], v[48:63]
    ds_read_b128 v[136:139], v242
    v_xor_b32 v242, 256, v242
    s_waitcnt lgkmcnt(7)
    v_mfma_f32_32x32x16_bf16 v[48:63], a[60:63], v[188:191], v[48:63]
    ds_read_b128 v[140:143], v243
    v_xor_b32 v243, 256, v243
    s_waitcnt vmcnt(8)
    ds_read_b128 a[80:83], v36 offset:5120
    ds_read_b128 a[84:87], v37 offset:5120
    ds_read_b128 a[88:91], v38 offset:5120
    ds_read_b128 a[92:95], v39 offset:5120
    s_waitcnt lgkmcnt(7)
    v_mfma_f32_32x32x16_bf16 v[48:63], a[64:67], v[128:131], v[48:63]
    ds_read_b128 v[144:147], v244
    v_xor_b32 v244, 256, v244
    s_waitcnt lgkmcnt(7)
    v_mfma_f32_32x32x16_bf16 v[48:63], a[68:71], v[132:135], v[48:63]
    ds_read_b128 v[148:151], v245
    v_xor_b32 v245, 256, v245
    s_waitcnt lgkmcnt(7)
    v_mfma_f32_32x32x16_bf16 v[48:63], a[72:75], v[136:139], v[48:63]
    ds_read_b128 v[152:155], v246
    v_xor_b32 v246, 256, v246
    s_waitcnt lgkmcnt(7)
    v_mfma_f32_32x32x16_bf16 v[48:63], a[76:79], v[140:143], v[48:63]
    ds_read_b128 v[156:159], v247
    v_xor_b32 v247, 256, v247
    ds_read_b128 v[160:163], v240
    s_waitcnt vmcnt(4)
    ds_read_b128 a[96:99], v36 offset:6144
    ds_read_b128 a[100:103], v37 offset:6144
    ds_read_b128 a[104:107], v38 offset:6144
    ds_read_b128 a[108:111], v39 offset:6144
    s_waitcnt lgkmcnt(8)
    v_mfma_f32_32x32x16_bf16 v[48:63], a[80:83], v[144:147], v[48:63]
    ds_read_b128 v[164:167], v241
    ds_read_b128 v[168:171], v242
    s_waitcnt lgkmcnt(9)
    v_mfma_f32_32x32x16_bf16 v[48:63], a[84:87], v[148:151], v[48:63]
    ds_read_b128 v[172:175], v243
    ds_read_b128 v[176:179], v244
    s_waitcnt lgkmcnt(10)
    v_mfma_f32_32x32x16_bf16 v[48:63], a[88:91], v[152:155], v[48:63]
    ds_read_b128 v[180:183], v245
    ds_read_b128 v[184:187], v246
    s_waitcnt lgkmcnt(11)
    v_mfma_f32_32x32x16_bf16 v[48:63], a[92:95], v[156:159], v[48:63]
    ds_read_b128 v[188:191], v247
    s_waitcnt vmcnt(0)
    ds_read_b128 a[112:115], v36 offset:7168
    ds_read_b128 a[116:119], v37 offset:7168
    ds_read_b128 a[120:123], v38 offset:7168
    ds_read_b128 a[124:127], v39 offset:7168
    s_waitcnt lgkmcnt(15)
    s_waitcnt lgkmcnt(14)
    v_mfma_f32_32x32x16_bf16 v[48:63], a[96:99], v[160:163], v[48:63]
    s_waitcnt lgkmcnt(10)
    v_mfma_f32_32x32x16_bf16 v[48:63], a[100:103], v[164:167], v[48:63]
    s_waitcnt lgkmcnt(9)
    v_mfma_f32_32x32x16_bf16 v[48:63], a[104:107], v[168:171], v[48:63]
    s_waitcnt lgkmcnt(8)
    v_mfma_f32_32x32x16_bf16 v[48:63], a[108:111], v[172:175], v[48:63]
    s_waitcnt lgkmcnt(4)
    s_barrier
    s_waitcnt lgkmcnt(3)
    v_mfma_f32_32x32x16_bf16 v[48:63], a[112:115], v[176:179], v[48:63]
    ds_read_b64_tr_b16 a[136:137], v194 offset:4096
    ds_read_b64_tr_b16 a[138:139], v195 offset:4096
    s_waitcnt lgkmcnt(4)
    v_mfma_f32_32x32x16_bf16 v[48:63], a[116:119], v[180:183], v[48:63]
    ds_read_b64_tr_b16 a[140:141], v194 offset:38912
    ds_read_b64_tr_b16 a[142:143], v195 offset:38912
    s_waitcnt lgkmcnt(5)
    v_mfma_f32_32x32x16_bf16 v[48:63], a[120:123], v[184:187], v[48:63]
    ds_read_b64_tr_b16 a[152:153], v194 offset:5120
    ds_read_b64_tr_b16 a[154:155], v195 offset:5120
    s_waitcnt lgkmcnt(6)
    v_mfma_f32_32x32x16_bf16 v[48:63], a[124:127], v[188:191], v[48:63]
    ds_read_b64_tr_b16 a[156:157], v194 offset:39936
    ds_read_b64_tr_b16 a[158:159], v195 offset:39936
    ds_read_b64_tr_b16 a[168:169], v194 offset:6144
    ds_read_b64_tr_b16 a[170:171], v195 offset:6144
    ds_read_b64_tr_b16 a[172:173], v194 offset:36864
    ds_read_b64_tr_b16 a[174:175], v195 offset:36864
    ds_read_b64_tr_b16 a[184:185], v194 offset:7168
    ds_read_b64_tr_b16 a[186:187], v195 offset:7168
    ds_read_b64_tr_b16 a[188:189], v194 offset:37888
    ds_read_b64_tr_b16 a[190:191], v195 offset:37888
    ds_read_b64_tr_b16 a[192:193], v192 offset:4096
    ds_read_b64_tr_b16 a[194:195], v193 offset:4096
    ds_read_b64_tr_b16 a[196:197], v192 offset:38912
    ds_read_b64_tr_b16 a[198:199], v193 offset:38912
    v_max3_f32 v3, v48, v49, v50
    v_max3_f32 v4, v51, v52, v53
    v_max3_f32 v3, v3, v54, v55
    v_max3_f32 v4, v4, v56, v57
    v_max3_f32 v3, v3, v58, v59
    v_max3_f32 v4, v4, v60, v61
    v_max3_f32 v3, v3, v62, v63
    v_max_f32 v3, v3, v4
    ds_write_b32 v222, v3
    ds_write_b128 v209, v[204:207]
    buffer_load_dwordx2 v[8:9], v212, s[20:23], s7 offen sc1
    v_mul_f32 v48, s37, v48
    v_mul_f32 v49, s37, v49
    v_mul_f32 v50, s37, v50
    v_mul_f32 v51, s37, v51
    v_mul_f32 v52, s37, v52
    v_mul_f32 v53, s37, v53
    v_mul_f32 v54, s37, v54
    v_mul_f32 v55, s37, v55
    s_waitcnt lgkmcnt(0)
    s_barrier
    ds_read_b128 v[24:27], v223
    ds_read_b128 v[28:31], v223 offset:16
    v_mul_f32 v56, s37, v56
    v_mul_f32 v57, s37, v57
    v_mul_f32 v58, s37, v58
    v_mul_f32 v59, s37, v59
    v_mul_f32 v60, s37, v60
    v_mul_f32 v61, s37, v61
    v_mul_f32 v62, s37, v62
    v_mul_f32 v63, s37, v63
    s_waitcnt lgkmcnt(1)
    v_max3_f32 v232, v24, v25, v26
    s_waitcnt lgkmcnt(0)
    v_max3_f32 v3, v27, v28, v29
    v_max3_f32 v232, v232, v30, v31
    v_max_f32 v232, v232, v3
    v_mul_f32 v232, s37, v232
    v_sub_f32 v48, v48, v232
    v_sub_f32 v49, v49, v232
    v_sub_f32 v50, v50, v232
    v_sub_f32 v51, v51, v232
    v_sub_f32 v52, v52, v232
    v_sub_f32 v53, v53, v232
    v_sub_f32 v54, v54, v232
    v_sub_f32 v55, v55, v232
    v_exp_f32 v48, v48
    v_exp_f32 v49, v49
    v_exp_f32 v50, v50
    v_exp_f32 v51, v51
    v_exp_f32 v52, v52
    v_exp_f32 v53, v53
    v_exp_f32 v54, v54
    v_exp_f32 v55, v55
    v_cvt_pk_bf16_f32 v24, v48, v49
    v_cvt_pk_bf16_f32 v25, v50, v51
    v_cvt_pk_bf16_f32 v26, v52, v53
    v_cvt_pk_bf16_f32 v27, v54, v55
    ds_write_b128 v226, v[24:27] offset:0
    v_sub_f32 v56, v56, v232
    v_sub_f32 v57, v57, v232
    v_sub_f32 v58, v58, v232
    v_sub_f32 v59, v59, v232
    v_sub_f32 v60, v60, v232
    v_sub_f32 v61, v61, v232
    v_sub_f32 v62, v62, v232
    v_sub_f32 v63, v63, v232
    v_exp_f32 v56, v56
    v_exp_f32 v57, v57
    v_exp_f32 v58, v58
    v_exp_f32 v59, v59
    v_exp_f32 v60, v60
    v_exp_f32 v61, v61
    v_exp_f32 v62, v62
    v_exp_f32 v63, v63
    v_cvt_pk_bf16_f32 v28, v56, v57
    v_cvt_pk_bf16_f32 v29, v58, v59
    v_cvt_pk_bf16_f32 v30, v60, v61
    v_cvt_pk_bf16_f32 v31, v62, v63
    ds_write_b128 v226, v[28:31] offset:512
    v_pk_add_f32 v[48:49], v[48:49], v[56:57]
    v_pk_add_f32 v[50:51], v[50:51], v[58:59]
    v_pk_add_f32 v[52:53], v[52:53], v[60:61]
    v_pk_add_f32 v[54:55], v[54:55], v[62:63]
    v_pk_add_f32 v[48:49], v[48:49], v[52:53]
    v_pk_add_f32 v[50:51], v[50:51], v[54:55]
    v_pk_add_f32 v[48:49], v[48:49], v[50:51]
    v_add_f32 v48, v48, v49
    ds_write_b32 v222, v48 offset:1024
    s_waitcnt lgkmcnt(0)
    s_barrier
    ds_read_b128 v[128:131], v227 offset:0
    ds_read_b128 v[136:139], v227 offset:2048
    ds_read_b128 v[144:147], v227 offset:4096
    ds_read_b128 v[152:155], v227 offset:6144
    ds_read_b128 v[48:51], v223 offset:1024
    ds_read_b128 v[52:55], v223 offset:1040
    ds_read_b128 v[132:135], v227 offset:1024
    ds_read_b128 v[140:143], v227 offset:3072
    ds_read_b128 v[148:151], v227 offset:5120
    ds_read_b128 v[156:159], v227 offset:7168
    s_waitcnt lgkmcnt(9)
    v_mfma_f32_16x16x32_bf16 v[64:67], v[128:131], a[128:131], 0
    ds_read_b64_tr_b16 a[208:209], v192 offset:5120
    ds_read_b64_tr_b16 a[210:211], v193 offset:5120
    s_waitcnt lgkmcnt(10)
    v_mfma_f32_16x16x32_bf16 v[64:67], v[136:139], a[132:135], v[64:67]
    ds_read_b64_tr_b16 a[212:213], v192 offset:39936
    ds_read_b64_tr_b16 a[214:215], v193 offset:39936
    s_waitcnt lgkmcnt(11)
    v_mfma_f32_16x16x32_bf16 v[64:67], v[144:147], a[136:139], v[64:67]
    ds_read_b64_tr_b16 a[224:225], v192 offset:6144
    ds_read_b64_tr_b16 a[226:227], v193 offset:6144
    s_waitcnt lgkmcnt(12)
    v_mfma_f32_16x16x32_bf16 v[64:67], v[152:155], a[140:143], v[64:67]
    s_waitcnt lgkmcnt(10)
    v_add_f32 v48, v48, v52
    v_add_f32 v49, v49, v53
    v_mfma_f32_16x16x32_bf16 v[68:71], v[128:131], a[144:147], 0
    v_add_f32 v50, v50, v54
    v_add_f32 v51, v51, v55
    v_mfma_f32_16x16x32_bf16 v[68:71], v[136:139], a[148:151], v[68:71]
    v_add_f32 v48, v48, v50
    v_add_f32 v49, v49, v51
    v_mfma_f32_16x16x32_bf16 v[68:71], v[144:147], a[152:155], v[68:71]
    v_add_f32 v233, v48, v49
    v_mfma_f32_16x16x32_bf16 v[68:71], v[152:155], a[156:159], v[68:71]
    s_mov_b64 exec, s[62:63]
    buffer_store_dwordx4 v[232:235], v228, s[20:23], s32 offen sc1
    s_mov_b64 exec, -1
    s_waitcnt lgkmcnt(9)
    v_mfma_f32_16x16x32_bf16 v[96:99], v[132:135], a[128:131], 0
    ds_read_b64_tr_b16 a[228:229], v192 offset:36864
    ds_read_b64_tr_b16 a[230:231], v193 offset:36864
    s_waitcnt lgkmcnt(10)
    v_mfma_f32_16x16x32_bf16 v[96:99], v[140:143], a[132:135], v[96:99]
    ds_read_b64_tr_b16 a[240:241], v192 offset:7168
    ds_read_b64_tr_b16 a[242:243], v193 offset:7168
    s_waitcnt lgkmcnt(11)
    v_mfma_f32_16x16x32_bf16 v[96:99], v[148:151], a[136:139], v[96:99]
    ds_read_b64_tr_b16 a[244:245], v192 offset:37888
    ds_read_b64_tr_b16 a[246:247], v193 offset:37888
    s_waitcnt lgkmcnt(12)
    v_mfma_f32_16x16x32_bf16 v[96:99], v[156:159], a[140:143], v[96:99]
    v_mfma_f32_16x16x32_bf16 v[100:103], v[132:135], a[144:147], 0
    v_mfma_f32_16x16x32_bf16 v[100:103], v[140:143], a[148:151], v[100:103]
    v_cvt_pk_bf16_f32 v160, v64, v68
    v_cvt_pk_bf16_f32 v161, v65, v69
    v_mfma_f32_16x16x32_bf16 v[100:103], v[148:151], a[152:155], v[100:103]
    v_cvt_pk_bf16_f32 v162, v66, v70
    v_cvt_pk_bf16_f32 v163, v67, v71
    v_mfma_f32_16x16x32_bf16 v[100:103], v[156:159], a[156:159], v[100:103]
    v_bfi_b32 v160, v215, v20, v160
    v_bfi_b32 v161, v215, v21, v161
    v_mfma_f32_16x16x32_bf16 v[72:75], v[128:131], a[160:163], 0
    v_bfi_b32 v162, v215, v22, v162
    v_bfi_b32 v163, v215, v23, v163
    v_mfma_f32_16x16x32_bf16 v[72:75], v[136:139], a[164:167], v[72:75]
    buffer_store_dwordx4 v[160:163], v229, s[20:23], s4 offen offset:0 sc1
    v_mfma_f32_16x16x32_bf16 v[72:75], v[144:147], a[168:171], v[72:75]
    v_mfma_f32_16x16x32_bf16 v[72:75], v[152:155], a[172:175], v[72:75]
    v_mfma_f32_16x16x32_bf16 v[76:79], v[128:131], a[176:179], 0
    v_mfma_f32_16x16x32_bf16 v[76:79], v[136:139], a[180:183], v[76:79]
    v_cvt_pk_bf16_f32 v164, v96, v100
    v_cvt_pk_bf16_f32 v165, v97, v101
    v_mfma_f32_16x16x32_bf16 v[76:79], v[144:147], a[184:187], v[76:79]
    v_cvt_pk_bf16_f32 v166, v98, v102
    v_cvt_pk_bf16_f32 v167, v99, v103
    v_mfma_f32_16x16x32_bf16 v[76:79], v[152:155], a[188:191], v[76:79]
    v_bfi_b32 v164, v215, v20, v164
    v_bfi_b32 v165, v215, v21, v165
    v_mfma_f32_16x16x32_bf16 v[104:107], v[132:135], a[160:163], 0
    v_bfi_b32 v166, v215, v22, v166
    v_bfi_b32 v167, v215, v23, v167
    v_mfma_f32_16x16x32_bf16 v[104:107], v[140:143], a[164:167], v[104:107]
    buffer_store_dwordx4 v[164:167], v229, s[20:23], s5 offen offset:0 sc1
    v_mfma_f32_16x16x32_bf16 v[104:107], v[148:151], a[168:171], v[104:107]
    v_mfma_f32_16x16x32_bf16 v[104:107], v[156:159], a[172:175], v[104:107]
    v_mfma_f32_16x16x32_bf16 v[108:111], v[132:135], a[176:179], 0
    v_mfma_f32_16x16x32_bf16 v[108:111], v[140:143], a[180:183], v[108:111]
    v_cvt_pk_bf16_f32 v168, v72, v76
    v_cvt_pk_bf16_f32 v169, v73, v77
    v_mfma_f32_16x16x32_bf16 v[108:111], v[148:151], a[184:187], v[108:111]
    v_cvt_pk_bf16_f32 v170, v74, v78
    v_cvt_pk_bf16_f32 v171, v75, v79
    v_mfma_f32_16x16x32_bf16 v[108:111], v[156:159], a[188:191], v[108:111]
    v_bfi_b32 v168, v215, v20, v168
    v_bfi_b32 v169, v215, v21, v169
    v_mfma_f32_16x16x32_bf16 v[80:83], v[128:131], a[192:195], 0
    v_bfi_b32 v170, v215, v22, v170
    v_bfi_b32 v171, v215, v23, v171
    v_mfma_f32_16x16x32_bf16 v[80:83], v[136:139], a[196:199], v[80:83]
    buffer_store_dwordx4 v[168:171], v229, s[20:23], s4 offen offset:256 sc1
    v_mfma_f32_16x16x32_bf16 v[80:83], v[144:147], a[200:203], v[80:83]
    v_mfma_f32_16x16x32_bf16 v[80:83], v[152:155], a[204:207], v[80:83]
    s_waitcnt lgkmcnt(10)
    v_mfma_f32_16x16x32_bf16 v[84:87], v[128:131], a[208:211], 0
    s_waitcnt lgkmcnt(8)
    v_mfma_f32_16x16x32_bf16 v[84:87], v[136:139], a[212:215], v[84:87]
    v_cvt_pk_bf16_f32 v172, v104, v108
    v_cvt_pk_bf16_f32 v173, v105, v109
    v_mfma_f32_16x16x32_bf16 v[84:87], v[144:147], a[216:219], v[84:87]
    v_cvt_pk_bf16_f32 v174, v106, v110
    v_cvt_pk_bf16_f32 v175, v107, v111
    v_mfma_f32_16x16x32_bf16 v[84:87], v[152:155], a[220:223], v[84:87]
    v_bfi_b32 v172, v215, v20, v172
    v_bfi_b32 v173, v215, v21, v173
    v_mfma_f32_16x16x32_bf16 v[112:115], v[132:135], a[192:195], 0
    v_bfi_b32 v174, v215, v22, v174
    v_bfi_b32 v175, v215, v23, v175
    v_mfma_f32_16x16x32_bf16 v[112:115], v[140:143], a[196:199], v[112:115]
    buffer_store_dwordx4 v[172:175], v229, s[20:23], s5 offen offset:256 sc1
    v_mfma_f32_16x16x32_bf16 v[112:115], v[148:151], a[200:203], v[112:115]
    v_mfma_f32_16x16x32_bf16 v[112:115], v[156:159], a[204:207], v[112:115]
    v_mfma_f32_16x16x32_bf16 v[116:119], v[132:135], a[208:211], 0
    v_mfma_f32_16x16x32_bf16 v[116:119], v[140:143], a[212:215], v[116:119]
    v_cvt_pk_bf16_f32 v176, v80, v84
    v_cvt_pk_bf16_f32 v177, v81, v85
    v_mfma_f32_16x16x32_bf16 v[116:119], v[148:151], a[216:219], v[116:119]
    v_cvt_pk_bf16_f32 v178, v82, v86
    v_cvt_pk_bf16_f32 v179, v83, v87
    v_mfma_f32_16x16x32_bf16 v[116:119], v[156:159], a[220:223], v[116:119]
    v_bfi_b32 v176, v215, v20, v176
    v_bfi_b32 v177, v215, v21, v177
    s_waitcnt lgkmcnt(6)
    v_mfma_f32_16x16x32_bf16 v[88:91], v[128:131], a[224:227], 0
    v_bfi_b32 v178, v215, v22, v178
    v_bfi_b32 v179, v215, v23, v179
    s_waitcnt lgkmcnt(4)
    v_mfma_f32_16x16x32_bf16 v[88:91], v[136:139], a[228:231], v[88:91]
    buffer_store_dwordx4 v[176:179], v229, s[20:23], s4 offen offset:512 sc1
    v_mfma_f32_16x16x32_bf16 v[88:91], v[144:147], a[232:235], v[88:91]
    v_mfma_f32_16x16x32_bf16 v[88:91], v[152:155], a[236:239], v[88:91]
    s_waitcnt lgkmcnt(2)
    v_mfma_f32_16x16x32_bf16 v[92:95], v[128:131], a[240:243], 0
    s_waitcnt lgkmcnt(0)
    v_mfma_f32_16x16x32_bf16 v[92:95], v[136:139], a[244:247], v[92:95]
    v_cvt_pk_bf16_f32 v180, v112, v116
    v_cvt_pk_bf16_f32 v181, v113, v117
    v_mfma_f32_16x16x32_bf16 v[92:95], v[144:147], a[248:251], v[92:95]
    v_cvt_pk_bf16_f32 v182, v114, v118
    v_cvt_pk_bf16_f32 v183, v115, v119
    v_mfma_f32_16x16x32_bf16 v[92:95], v[152:155], a[252:255], v[92:95]
    v_bfi_b32 v180, v215, v20, v180
    v_bfi_b32 v181, v215, v21, v181
    v_mfma_f32_16x16x32_bf16 v[120:123], v[132:135], a[224:227], 0
    v_bfi_b32 v182, v215, v22, v182
    v_bfi_b32 v183, v215, v23, v183
    v_mfma_f32_16x16x32_bf16 v[120:123], v[140:143], a[228:231], v[120:123]
    buffer_store_dwordx4 v[180:183], v229, s[20:23], s5 offen offset:512 sc1
    v_mfma_f32_16x16x32_bf16 v[120:123], v[148:151], a[232:235], v[120:123]
    v_mfma_f32_16x16x32_bf16 v[120:123], v[156:159], a[236:239], v[120:123]
    v_mfma_f32_16x16x32_bf16 v[124:127], v[132:135], a[240:243], 0
    v_mfma_f32_16x16x32_bf16 v[124:127], v[140:143], a[244:247], v[124:127]
    v_cvt_pk_bf16_f32 v184, v88, v92
    v_cvt_pk_bf16_f32 v185, v89, v93
    v_mfma_f32_16x16x32_bf16 v[124:127], v[148:151], a[248:251], v[124:127]
    v_cvt_pk_bf16_f32 v186, v90, v94
    v_cvt_pk_bf16_f32 v187, v91, v95
    v_mfma_f32_16x16x32_bf16 v[124:127], v[156:159], a[252:255], v[124:127]
    v_bfi_b32 v184, v215, v20, v184
    v_bfi_b32 v185, v215, v21, v185
    v_bfi_b32 v186, v215, v22, v186
    v_bfi_b32 v187, v215, v23, v187
    buffer_store_dwordx4 v[184:187], v229, s[20:23], s4 offen offset:768 sc1
    s_mov_b32 s48, 0
    s_nop 1
    v_cvt_pk_bf16_f32 v188, v120, v124
    v_cvt_pk_bf16_f32 v189, v121, v125
    v_cvt_pk_bf16_f32 v190, v122, v126
    v_cvt_pk_bf16_f32 v191, v123, v127
    v_bfi_b32 v188, v215, v20, v188
    v_bfi_b32 v189, v215, v21, v189
    v_bfi_b32 v190, v215, v22, v190
    v_bfi_b32 v191, v215, v23, v191
    buffer_store_dwordx4 v[188:191], v229, s[20:23], s5 offen offset:768 sc1
    s_add_u32 m0, s54, 0
    s_add_u32 s49, s60, 0
    buffer_load_dwordx4 v10, s[28:31], s49 offen nt lds
    s_add_u32 m0, s54, 1024
    s_add_u32 s49, s60, 128
    buffer_load_dwordx4 v10, s[28:31], s49 offen nt lds
    s_add_u32 m0, s54, 8192
    s_add_u32 s49, s60, 65536
    buffer_load_dwordx4 v10, s[28:31], s49 offen nt lds
    s_add_u32 m0, s54, 9216
    s_add_u32 s49, s60, 65664
    buffer_load_dwordx4 v10, s[28:31], s49 offen nt lds
    s_add_u32 m0, s54, 16384
    s_add_u32 s49, s60, 16384
    buffer_load_dwordx4 v10, s[28:31], s49 offen nt lds
    s_add_u32 m0, s54, 17408
    s_add_u32 s49, s60, 16512
    buffer_load_dwordx4 v10, s[28:31], s49 offen nt lds
    s_add_u32 m0, s54, 24576
    s_add_u32 s49, s60, 81920
    buffer_load_dwordx4 v10, s[28:31], s49 offen nt lds
    s_add_u32 m0, s54, 25600
    s_add_u32 s49, s60, 82048
    buffer_load_dwordx4 v10, s[28:31], s49 offen nt lds
    buffer_load_dwordx3 v[24:26], v231, s[20:23], s59 offen sc1
    buffer_load_dwordx3 v[28:30], v231, s[20:23], s36 offen sc1
    s_waitcnt vmcnt(0)
L_ml_4:
    v_xor_b32 v3, s40, v26
    v_bitop3_b32 v3, v3, v30, s40 bitop3:0xf6
    v_cmp_ne_u32 vcc, 0, v3
    s_cbranch_vccz L_mlok_5
    buffer_load_dwordx3 v[24:26], v231, s[20:23], s59 offen sc1
    buffer_load_dwordx3 v[28:30], v231, s[20:23], s36 offen sc1
    s_add_u32 s48, s48, 1
    s_cmp_gt_u32 s48, 131072
    s_cbranch_scc1 L_end
    s_waitcnt vmcnt(0)
    s_branch L_ml_4
L_mlok_5:
    s_add_u32 s49, s58, 0
    buffer_load_dwordx4 v[128:131], v230, s[20:23], s49 offen sc1
    s_add_u32 s49, s58, 131072
    buffer_load_dwordx4 v[132:135], v230, s[20:23], s49 offen sc1
    s_add_u32 s49, s58, 262144
    buffer_load_dwordx4 v[136:139], v230, s[20:23], s49 offen sc1
    s_add_u32 s49, s58, 393216
    buffer_load_dwordx4 v[140:143], v230, s[20:23], s49 offen sc1
    s_add_u32 s49, s58, 524288
    buffer_load_dwordx4 v[144:147], v230, s[20:23], s49 offen sc1
    s_add_u32 s49, s58, 655360
    buffer_load_dwordx4 v[148:151], v230, s[20:23], s49 offen sc1
    s_add_u32 s49, s58, 786432
    buffer_load_dwordx4 v[152:155], v230, s[20:23], s49 offen sc1
    s_add_u32 s49, s58, 917504
    buffer_load_dwordx4 v[156:159], v230, s[20:23], s49 offen sc1
    ds_read_b64_tr_b16 a[0:1], v44 offset:0
    ds_read_b64_tr_b16 a[4:5], v45 offset:0
    ds_read_b64_tr_b16 a[8:9], v46 offset:0
    ds_read_b64_tr_b16 a[12:13], v47 offset:0
    ds_read_b64_tr_b16 a[2:3], v44 offset:16384
    ds_read_b64_tr_b16 a[6:7], v45 offset:16384
    ds_read_b64_tr_b16 a[10:11], v46 offset:16384
    ds_read_b64_tr_b16 a[14:15], v47 offset:16384
    ds_read_b64_tr_b16 a[16:17], v44 offset:1024
    ds_read_b64_tr_b16 a[20:21], v45 offset:1024
    ds_read_b64_tr_b16 a[24:25], v46 offset:1024
    ds_read_b64_tr_b16 a[28:29], v47 offset:1024
    ds_read_b64_tr_b16 a[18:19], v44 offset:17408
    ds_read_b64_tr_b16 a[22:23], v45 offset:17408
    ds_read_b64_tr_b16 a[26:27], v46 offset:17408
    ds_read_b64_tr_b16 a[30:31], v47 offset:17408
    v_xor_b32 v3, s40, v9
    v_bitop3_b32 v3, v3, v8, s56 bitop3:0xf6
    v_cmp_ne_u32 s[38:39], 0, v3
    v_max_f32 v48, v24, v28
    s_nop 1
    v_max_f32_dpp v48, v48, v48 quad_perm:[1,0,3,2] row_mask:0xf bank_mask:0xf
    s_nop 1
    v_max_f32_dpp v48, v48, v48 row_ror:8 row_mask:0xf bank_mask:0xf
    v_mov_b32 v3, v48
    s_nop 1
    v_permlane16_swap_b32 v48, v3
    v_max_f32 v48, v48, v3
    v_mov_b32 v3, v48
    s_nop 1
    v_permlane32_swap_b32 v48, v3
    v_max_f32 v48, v48, v3
    v_sub_f32 v24, v24, v48
    v_sub_f32 v28, v28, v48
    v_exp_f32 v24, v24
    v_exp_f32 v28, v28
    s_nop 0
    v_cvt_pk_bf16_f32 v24, v24, v24
    v_cvt_pk_bf16_f32 v28, v28, v28
    v_and_b32 v26, 0xffff0000, v24
    v_and_b32 v30, 0xffff0000, v28
    v_mov_b32_dpp v27, v24 row_ror:8 row_mask:0xf bank_mask:0xf
    v_mov_b32_dpp v31, v28 row_ror:8 row_mask:0xf bank_mask:0xf
    v_mul_f32 v49, v26, v25
    v_fmac_f32 v49, v30, v29
    v_and_b32_dpp v64, v24, v16 quad_perm:[0,0,2,2] row_mask:0xf bank_mask:0xf
    v_and_b32_dpp v65, v24, v17 quad_perm:[0,0,2,2] row_mask:0xf bank_mask:0xf
    v_and_b32_dpp v66, v24, v18 quad_perm:[0,0,2,2] row_mask:0xf bank_mask:0xf
    v_and_b32_dpp v67, v24, v19 quad_perm:[0,0,2,2] row_mask:0xf bank_mask:0xf
    v_and_b32_dpp v68, v24, v16 quad_perm:[1,1,3,3] row_mask:0xf bank_mask:0xf
    v_and_b32_dpp v69, v24, v17 quad_perm:[1,1,3,3] row_mask:0xf bank_mask:0xf
    v_and_b32_dpp v70, v24, v18 quad_perm:[1,1,3,3] row_mask:0xf bank_mask:0xf
    v_and_b32_dpp v71, v24, v19 quad_perm:[1,1,3,3] row_mask:0xf bank_mask:0xf
    v_and_b32_dpp v72, v27, v16 quad_perm:[0,0,2,2] row_mask:0xf bank_mask:0xf
    v_and_b32_dpp v73, v27, v17 quad_perm:[0,0,2,2] row_mask:0xf bank_mask:0xf
    v_and_b32_dpp v74, v27, v18 quad_perm:[0,0,2,2] row_mask:0xf bank_mask:0xf
    v_and_b32_dpp v75, v27, v19 quad_perm:[0,0,2,2] row_mask:0xf bank_mask:0xf
    v_and_b32_dpp v76, v27, v16 quad_perm:[1,1,3,3] row_mask:0xf bank_mask:0xf
    v_and_b32_dpp v77, v27, v17 quad_perm:[1,1,3,3] row_mask:0xf bank_mask:0xf
    v_and_b32_dpp v78, v27, v18 quad_perm:[1,1,3,3] row_mask:0xf bank_mask:0xf
    v_and_b32_dpp v79, v27, v19 quad_perm:[1,1,3,3] row_mask:0xf bank_mask:0xf
    v_and_b32_dpp v80, v28, v16 quad_perm:[0,0,2,2] row_mask:0xf bank_mask:0xf
    v_and_b32_dpp v81, v28, v17 quad_perm:[0,0,2,2] row_mask:0xf bank_mask:0xf
    v_and_b32_dpp v82, v28, v18 quad_perm:[0,0,2,2] row_mask:0xf bank_mask:0xf
    v_and_b32_dpp v83, v28, v19 quad_perm:[0,0,2,2] row_mask:0xf bank_mask:0xf
    v_and_b32_dpp v84, v28, v16 quad_perm:[1,1,3,3] row_mask:0xf bank_mask:0xf
    v_and_b32_dpp v85, v28, v17 quad_perm:[1,1,3,3] row_mask:0xf bank_mask:0xf
    v_and_b32_dpp v86, v28, v18 quad_perm:[1,1,3,3] row_mask:0xf bank_mask:0xf
    v_and_b32_dpp v87, v28, v19 quad_perm:[1,1,3,3] row_mask:0xf bank_mask:0xf
    v_and_b32_dpp v88, v31, v16 quad_perm:[0,0,2,2] row_mask:0xf bank_mask:0xf
    v_and_b32_dpp v89, v31, v17 quad_perm:[0,0,2,2] row_mask:0xf bank_mask:0xf
    v_and_b32_dpp v90, v31, v18 quad_perm:[0,0,2,2] row_mask:0xf bank_mask:0xf
    v_and_b32_dpp v91, v31, v19 quad_perm:[0,0,2,2] row_mask:0xf bank_mask:0xf
    v_and_b32_dpp v92, v31, v16 quad_perm:[1,1,3,3] row_mask:0xf bank_mask:0xf
    v_and_b32_dpp v93, v31, v17 quad_perm:[1,1,3,3] row_mask:0xf bank_mask:0xf
    v_and_b32_dpp v94, v31, v18 quad_perm:[1,1,3,3] row_mask:0xf bank_mask:0xf
    v_and_b32_dpp v95, v31, v19 quad_perm:[1,1,3,3] row_mask:0xf bank_mask:0xf
    s_nop 1
    v_add_f32_dpp v49, v49, v49 quad_perm:[1,0,3,2] row_mask:0xf bank_mask:0xf
    s_nop 1
    v_add_f32_dpp v49, v49, v49 row_ror:8 row_mask:0xf bank_mask:0xf
    v_mov_b32 v3, v49
    s_nop 1
    v_permlane16_swap_b32 v49, v3
    v_add_f32 v49, v49, v3
    v_mov_b32 v3, v49
    s_nop 1
    v_permlane32_swap_b32 v49, v3
    v_add_f32 v49, v49, v3
    ds_write_b64 v210, v[48:49]
    s_mov_b32 s48, 0
L_pc_7:
    s_waitcnt vmcnt(7)
    v_xor_b32 v3, v128, v40
    v_bitop3_b32 v3, v3, v129, v41 bitop3:0xf6
    v_bitop3_b32 v3, v3, v130, v42 bitop3:0xf6
    v_bitop3_b32 v3, v3, v131, v43 bitop3:0xf6
    v_and_b32 v3, 0x10001, v3
    v_cmp_ne_u32 vcc, 0, v3
    s_cbranch_vccnz L_pr_6
    v_mfma_f32_16x16x32_bf16 v[32:35], v[64:67], v[128:131], 0
L_pc_9:
    s_waitcnt vmcnt(6)
    v_xor_b32 v3, v132, v40
    v_bitop3_b32 v3, v3, v133, v41 bitop3:0xf6
    v_bitop3_b32 v3, v3, v134, v42 bitop3:0xf6
    v_bitop3_b32 v3, v3, v135, v43 bitop3:0xf6
    v_and_b32 v3, 0x10001, v3
    v_cmp_ne_u32 vcc, 0, v3
    s_cbranch_vccnz L_pr_8
    v_mfma_f32_16x16x32_bf16 v[32:35], v[68:71], v[132:135], v[32:35]
L_pc_11:
    s_waitcnt vmcnt(5)
    v_xor_b32 v3, v136, v40
    v_bitop3_b32 v3, v3, v137, v41 bitop3:0xf6
    v_bitop3_b32 v3, v3, v138, v42 bitop3:0xf6
    v_bitop3_b32 v3, v3, v139, v43 bitop3:0xf6
    v_and_b32 v3, 0x10001, v3
    v_cmp_ne_u32 vcc, 0, v3
    s_cbranch_vccnz L_pr_10
    v_mfma_f32_16x16x32_bf16 v[32:35], v[72:75], v[136:139], v[32:35]
L_pc_13:
    s_waitcnt vmcnt(4)
    v_xor_b32 v3, v140, v40
    v_bitop3_b32 v3, v3, v141, v41 bitop3:0xf6
    v_bitop3_b32 v3, v3, v142, v42 bitop3:0xf6
    v_bitop3_b32 v3, v3, v143, v43 bitop3:0xf6
    v_and_b32 v3, 0x10001, v3
    v_cmp_ne_u32 vcc, 0, v3
    s_cbranch_vccnz L_pr_12
    v_mfma_f32_16x16x32_bf16 v[32:35], v[76:79], v[140:143], v[32:35]
L_pc_15:
    s_waitcnt vmcnt(3)
    v_xor_b32 v3, v144, v40
    v_bitop3_b32 v3, v3, v145, v41 bitop3:0xf6
    v_bitop3_b32 v3, v3, v146, v42 bitop3:0xf6
    v_bitop3_b32 v3, v3, v147, v43 bitop3:0xf6
    v_and_b32 v3, 0x10001, v3
    v_cmp_ne_u32 vcc, 0, v3
    s_cbranch_vccnz L_pr_14
    v_mfma_f32_16x16x32_bf16 v[32:35], v[80:83], v[144:147], v[32:35]
L_pc_17:
    s_waitcnt vmcnt(2)
    v_xor_b32 v3, v148, v40
    v_bitop3_b32 v3, v3, v149, v41 bitop3:0xf6
    v_bitop3_b32 v3, v3, v150, v42 bitop3:0xf6
    v_bitop3_b32 v3, v3, v151, v43 bitop3:0xf6
    v_and_b32 v3, 0x10001, v3
    v_cmp_ne_u32 vcc, 0, v3
    s_cbranch_vccnz L_pr_16
    v_mfma_f32_16x16x32_bf16 v[32:35], v[84:87], v[148:151], v[32:35]
L_pc_19:
    s_waitcnt vmcnt(1)
    v_xor_b32 v3, v152, v40
    v_bitop3_b32 v3, v3, v153, v41 bitop3:0xf6
    v_bitop3_b32 v3, v3, v154, v42 bitop3:0xf6
    v_bitop3_b32 v3, v3, v155, v43 bitop3:0xf6
    v_and_b32 v3, 0x10001, v3
    v_cmp_ne_u32 vcc, 0, v3
    s_cbranch_vccnz L_pr_18
    v_mfma_f32_16x16x32_bf16 v[32:35], v[88:91], v[152:155], v[32:35]
L_pc_21:
    s_waitcnt vmcnt(0)
    v_xor_b32 v3, v156, v40
    v_bitop3_b32 v3, v3, v157, v41 bitop3:0xf6
    v_bitop3_b32 v3, v3, v158, v42 bitop3:0xf6
    v_bitop3_b32 v3, v3, v159, v43 bitop3:0xf6
    v_and_b32 v3, 0x10001, v3
    v_cmp_ne_u32 vcc, 0, v3
    s_cbranch_vccnz L_pr_20
    v_mfma_f32_16x16x32_bf16 v[32:35], v[92:95], v[156:159], v[32:35]
    s_mov_b32 exec_hi, 0
    s_nop 6
    v_cvt_pk_bf16_f32 v32, v32, v33
    v_cvt_pk_bf16_f32 v33, v34, v35
    ds_write2st64_b32 v208, v32, v33 offset1:1
    s_mov_b32 exec_hi, -1
    s_waitcnt lgkmcnt(0)
    s_barrier
    ds_read_b128 v[64:67], v200
    ds_read_b128 v[24:27], v211
    ds_read_b128 v[28:31], v211 offset:16
    ds_read_b128 v[68:71], v201
    ds_read_b128 v[72:75], v202
    ds_read_b128 v[76:79], v203
    s_waitcnt lgkmcnt(5)
    v_mfma_f32_16x16x32_bf16 v[96:99], v[64:67], a[0:3], 0
    s_waitcnt lgkmcnt(3)
    v_max3_f32 v3, v24, v26, v28
    v_max_f32 v3, v3, v30
    v_mfma_f32_16x16x32_bf16 v[100:103], v[64:67], a[4:7], 0
    v_sub_f32 v24, v24, v3
    v_sub_f32 v26, v26, v3
    s_waitcnt lgkmcnt(2)
    v_mfma_f32_16x16x32_bf16 v[96:99], v[68:71], a[8:11], v[96:99]
    v_sub_f32 v28, v28, v3
    v_sub_f32 v30, v30, v3
    v_mfma_f32_16x16x32_bf16 v[100:103], v[68:71], a[12:15], v[100:103]
    v_exp_f32 v24, v24
    v_exp_f32 v26, v26
    s_waitcnt lgkmcnt(1)
    v_mfma_f32_16x16x32_bf16 v[96:99], v[72:75], a[16:19], v[96:99]
    v_exp_f32 v28, v28
    v_exp_f32 v30, v30
    v_mfma_f32_16x16x32_bf16 v[100:103], v[72:75], a[20:23], v[100:103]
    v_mul_f32 v3, v24, v25
    v_fmac_f32 v3, v26, v27
    s_waitcnt lgkmcnt(0)
    v_mfma_f32_16x16x32_bf16 v[96:99], v[76:79], a[24:27], v[96:99]
    v_fmac_f32 v3, v28, v29
    v_fmac_f32 v3, v30, v31
    v_mfma_f32_16x16x32_bf16 v[100:103], v[76:79], a[28:31], v[100:103]
    v_rcp_f32 v3, v3
    s_cmp_eq_u64 s[38:39], 0
    s_nop 2
    v_mul_f32 v32, v24, v96
    v_fmac_f32 v32, v26, v97
    v_fmac_f32 v32, v28, v98
    v_fmac_f32 v32, v30, v99
    v_mul_f32 v33, v24, v100
    v_fmac_f32 v33, v26, v101
    v_fmac_f32 v33, v28, v102
    v_fmac_f32 v33, v30, v103
    v_mul_f32 v32, v3, v32
    v_mul_f32 v33, v3, v33
    v_bfi_b32 v32, v214, v12, v32
    v_bfi_b32 v33, v214, v13, v33
    s_cbranch_scc0 L_cs_22
    buffer_store_dwordx2 v[32:33], v6, s[20:23], s6 offen
L_ce_23:
    s_barrier
    s_lshl_b32 s49, s3, 4
    s_add_u32 s49, s49, s45
    s_and_b32 s50, s49, 0xf8
    s_add_u32 s50, s50, s44
    s_cmp_ge_u32 s50, 20
    s_cbranch_scc1 L_fin
    s_and_b32 s49, s49, 7
    s_lshl_b32 s51, s50, 3
    s_add_u32 s51, s51, s49
    s_lshl_b32 s52, s51, 4
    s_add_u32 s52, s52, 327680
    s_add_u32 s53, s52, 163840
    v_mul_u32_u24 v3, 2560, v0
    s_lshr_b32 s54, s51, 4
    s_lshl_b32 s54, s54, 7
    s_and_b32 s51, s51, 15
    s_lshl_b32 s51, s51, 1
    s_add_u32 s54, s54, s51
    v_bfe_u32 v4, v0, 4, 1
    v_lshlrev_b32 v4, 6, v4
    v_lshrrev_b32 v5, 5, v0
    v_lshl_add_u32 v4, v5, 5, v4
    s_mov_b32 s48, 0
L_o_24:
    buffer_load_dwordx4 v[24:27], v3, s[20:23], s52 offen sc1
    buffer_load_dwordx4 v[28:31], v3, s[20:23], s53 offen sc1
    s_add_u32 s48, s48, 1
    s_cmp_gt_u32 s48, 131072
    s_cbranch_scc1 L_end
    s_waitcnt vmcnt(1)
    v_xor_b32 v5, s40, v24
    v_bitop3_b32 v5, v5, v25, s41 bitop3:0xf6
    v_bitop3_b32 v5, v5, v26, s42 bitop3:0xf6
    v_bitop3_b32 v5, v5, v27, s43 bitop3:0xf6
    s_waitcnt vmcnt(0)
    v_bitop3_b32 v5, v5, v28, s40 bitop3:0xf6
    v_bitop3_b32 v5, v5, v29, s41 bitop3:0xf6
    v_bitop3_b32 v5, v5, v30, s42 bitop3:0xf6
    v_bitop3_b32 v5, v5, v31, s43 bitop3:0xf6
    v_and_b32 v5, 0xff, v5
    v_cmp_ne_u32 vcc, 0, v5
    s_cbranch_vccnz L_o_24
    v_pk_add_f32 v[24:25], v[24:25], v[28:29]
    v_pk_add_f32 v[26:27], v[26:27], v[30:31]
    s_nop 0
    v_permlane32_swap_b32 v24, v25
    v_permlane32_swap_b32 v26, v27
    v_add_f32 v24, v24, v25
    v_add_f32 v26, v26, v27
    s_nop 1
    v_permlane16_swap_b32 v24, v26
    v_add_f32 v24, v24, v26
    s_nop 1
    v_add_f32_dpp v24, v24, v24 row_ror:8 row_mask:0xf bank_mask:0xf
    s_nop 1
    v_add_f32_dpp v24, v24, v24 row_ror:4 row_mask:0xf bank_mask:0xf
    s_nop 1
    v_add_f32_dpp v24, v24, v24 row_ror:2 row_mask:0xf bank_mask:0xf
    s_nop 1
    v_add_f32_dpp v24, v24, v24 row_ror:1 row_mask:0xf bank_mask:0xf
    v_cvt_pk_bf16_f32 v24, v24, v24
    s_mov_b32 exec_lo, 0x00010001
    s_mov_b32 exec_hi, 0x00010001
    buffer_store_short v24, v4, s[16:19], s54 offen
    s_or_b32 s49, s2, s3
    s_cmp_lg_u32 s49, 0
    s_cbranch_scc1 L_fin
    s_mov_b64 exec, 1
    buffer_store_dword v234, v11, s[20:23], 0 offen sc1
    s_branch L_fin
L_qr_3:
    buffer_load_dwordx4 v[64:67], v7, s[20:23], s34 offen offset:0 sc1
    buffer_load_dwordx4 v[68:71], v7, s[20:23], s34 offen offset:1024 sc1
    buffer_load_dwordx4 v[72:75], v7, s[20:23], s34 offen offset:2048 sc1
    buffer_load_dwordx4 v[76:79], v7, s[20:23], s34 offen offset:3072 sc1
    s_add_u32 s49, s34, 4096
    buffer_load_dwordx4 v[80:83], v7, s[20:23], s49 offen offset:0 sc1
    buffer_load_dwordx4 v[84:87], v7, s[20:23], s49 offen offset:1024 sc1
    buffer_load_dwordx4 v[88:91], v7, s[20:23], s49 offen offset:2048 sc1
    buffer_load_dwordx4 v[92:95], v7, s[20:23], s49 offen offset:3072 sc1
    s_add_u32 s48, s48, 1
    s_cmp_gt_u32 s48, 131072
    s_cbranch_scc1 L_end
    s_waitcnt vmcnt(7)
    ds_write_b128 v248, v[64:67] offset:0
    v_xor_b32 v2, v64, v196
    v_bitop3_b32 v2, v2, v65, v197 bitop3:0xf6
    v_bitop3_b32 v2, v2, v66, v198 bitop3:0xf6
    v_bitop3_b32 v2, v2, v67, v199 bitop3:0xf6
    s_waitcnt vmcnt(6)
    ds_write_b128 v249, v[68:71] offset:1024
    v_bitop3_b32 v2, v2, v68, v196 bitop3:0xf6
    v_bitop3_b32 v2, v2, v69, v197 bitop3:0xf6
    v_bitop3_b32 v2, v2, v70, v198 bitop3:0xf6
    v_bitop3_b32 v2, v2, v71, v199 bitop3:0xf6
    s_waitcnt vmcnt(5)
    ds_write_b128 v250, v[72:75] offset:2048
    v_bitop3_b32 v2, v2, v72, v196 bitop3:0xf6
    v_bitop3_b32 v2, v2, v73, v197 bitop3:0xf6
    v_bitop3_b32 v2, v2, v74, v198 bitop3:0xf6
    v_bitop3_b32 v2, v2, v75, v199 bitop3:0xf6
    s_waitcnt vmcnt(4)
    ds_write_b128 v251, v[76:79] offset:3072
    v_bitop3_b32 v2, v2, v76, v196 bitop3:0xf6
    v_bitop3_b32 v2, v2, v77, v197 bitop3:0xf6
    v_bitop3_b32 v2, v2, v78, v198 bitop3:0xf6
    v_bitop3_b32 v2, v2, v79, v199 bitop3:0xf6
    s_waitcnt vmcnt(3)
    ds_write_b128 v252, v[80:83] offset:4096
    v_bitop3_b32 v2, v2, v80, v196 bitop3:0xf6
    v_bitop3_b32 v2, v2, v81, v197 bitop3:0xf6
    v_bitop3_b32 v2, v2, v82, v198 bitop3:0xf6
    v_bitop3_b32 v2, v2, v83, v199 bitop3:0xf6
    s_waitcnt vmcnt(2)
    ds_write_b128 v253, v[84:87] offset:5120
    v_bitop3_b32 v2, v2, v84, v196 bitop3:0xf6
    v_bitop3_b32 v2, v2, v85, v197 bitop3:0xf6
    v_bitop3_b32 v2, v2, v86, v198 bitop3:0xf6
    v_bitop3_b32 v2, v2, v87, v199 bitop3:0xf6
    s_waitcnt vmcnt(1)
    ds_write_b128 v254, v[88:91] offset:6144
    v_bitop3_b32 v2, v2, v88, v196 bitop3:0xf6
    v_bitop3_b32 v2, v2, v89, v197 bitop3:0xf6
    v_bitop3_b32 v2, v2, v90, v198 bitop3:0xf6
    v_bitop3_b32 v2, v2, v91, v199 bitop3:0xf6
    s_waitcnt vmcnt(0)
    ds_write_b128 v255, v[92:95] offset:7168
    v_bitop3_b32 v2, v2, v92, v196 bitop3:0xf6
    v_bitop3_b32 v2, v2, v93, v197 bitop3:0xf6
    v_bitop3_b32 v2, v2, v94, v198 bitop3:0xf6
    v_bitop3_b32 v2, v2, v95, v199 bitop3:0xf6
    v_and_b32 v2, 0x10001, v2
    v_cmp_ne_u32 vcc, 0, v2
    s_waitcnt lgkmcnt(0)
    s_cbranch_vccnz L_qr_3
    s_branch L_q_2
L_pr_6:
    s_add_u32 s49, s58, 0
    buffer_load_dwordx4 v[128:131], v230, s[20:23], s49 offen sc1
    s_add_u32 s49, s58, 131072
    buffer_load_dwordx4 v[132:135], v230, s[20:23], s49 offen sc1
    s_add_u32 s49, s58, 262144
    buffer_load_dwordx4 v[136:139], v230, s[20:23], s49 offen sc1
    s_add_u32 s49, s58, 393216
    buffer_load_dwordx4 v[140:143], v230, s[20:23], s49 offen sc1
    s_add_u32 s49, s58, 524288
    buffer_load_dwordx4 v[144:147], v230, s[20:23], s49 offen sc1
    s_add_u32 s49, s58, 655360
    buffer_load_dwordx4 v[148:151], v230, s[20:23], s49 offen sc1
    s_add_u32 s49, s58, 786432
    buffer_load_dwordx4 v[152:155], v230, s[20:23], s49 offen sc1
    s_add_u32 s49, s58, 917504
    buffer_load_dwordx4 v[156:159], v230, s[20:23], s49 offen sc1
    s_add_u32 s48, s48, 1
    s_cmp_gt_u32 s48, 131072
    s_cbranch_scc1 L_end
    s_branch L_pc_7
L_pr_8:
    s_add_u32 s49, s58, 131072
    buffer_load_dwordx4 v[132:135], v230, s[20:23], s49 offen sc1
    s_add_u32 s49, s58, 262144
    buffer_load_dwordx4 v[136:139], v230, s[20:23], s49 offen sc1
    s_add_u32 s49, s58, 393216
    buffer_load_dwordx4 v[140:143], v230, s[20:23], s49 offen sc1
    s_add_u32 s49, s58, 524288
    buffer_load_dwordx4 v[144:147], v230, s[20:23], s49 offen sc1
    s_add_u32 s49, s58, 655360
    buffer_load_dwordx4 v[148:151], v230, s[20:23], s49 offen sc1
    s_add_u32 s49, s58, 786432
    buffer_load_dwordx4 v[152:155], v230, s[20:23], s49 offen sc1
    s_add_u32 s49, s58, 917504
    buffer_load_dwordx4 v[156:159], v230, s[20:23], s49 offen sc1
    s_add_u32 s48, s48, 1
    s_cmp_gt_u32 s48, 131072
    s_cbranch_scc1 L_end
    s_branch L_pc_9
L_pr_10:
    s_add_u32 s49, s58, 262144
    buffer_load_dwordx4 v[136:139], v230, s[20:23], s49 offen sc1
    s_add_u32 s49, s58, 393216
    buffer_load_dwordx4 v[140:143], v230, s[20:23], s49 offen sc1
    s_add_u32 s49, s58, 524288
    buffer_load_dwordx4 v[144:147], v230, s[20:23], s49 offen sc1
    s_add_u32 s49, s58, 655360
    buffer_load_dwordx4 v[148:151], v230, s[20:23], s49 offen sc1
    s_add_u32 s49, s58, 786432
    buffer_load_dwordx4 v[152:155], v230, s[20:23], s49 offen sc1
    s_add_u32 s49, s58, 917504
    buffer_load_dwordx4 v[156:159], v230, s[20:23], s49 offen sc1
    s_add_u32 s48, s48, 1
    s_cmp_gt_u32 s48, 131072
    s_cbranch_scc1 L_end
    s_branch L_pc_11
L_pr_12:
    s_add_u32 s49, s58, 393216
    buffer_load_dwordx4 v[140:143], v230, s[20:23], s49 offen sc1
    s_add_u32 s49, s58, 524288
    buffer_load_dwordx4 v[144:147], v230, s[20:23], s49 offen sc1
    s_add_u32 s49, s58, 655360
    buffer_load_dwordx4 v[148:151], v230, s[20:23], s49 offen sc1
    s_add_u32 s49, s58, 786432
    buffer_load_dwordx4 v[152:155], v230, s[20:23], s49 offen sc1
    s_add_u32 s49, s58, 917504
    buffer_load_dwordx4 v[156:159], v230, s[20:23], s49 offen sc1
    s_add_u32 s48, s48, 1
    s_cmp_gt_u32 s48, 131072
    s_cbranch_scc1 L_end
    s_branch L_pc_13
L_pr_14:
    s_add_u32 s49, s58, 524288
    buffer_load_dwordx4 v[144:147], v230, s[20:23], s49 offen sc1
    s_add_u32 s49, s58, 655360
    buffer_load_dwordx4 v[148:151], v230, s[20:23], s49 offen sc1
    s_add_u32 s49, s58, 786432
    buffer_load_dwordx4 v[152:155], v230, s[20:23], s49 offen sc1
    s_add_u32 s49, s58, 917504
    buffer_load_dwordx4 v[156:159], v230, s[20:23], s49 offen sc1
    s_add_u32 s48, s48, 1
    s_cmp_gt_u32 s48, 131072
    s_cbranch_scc1 L_end
    s_branch L_pc_15
L_pr_16:
    s_add_u32 s49, s58, 655360
    buffer_load_dwordx4 v[148:151], v230, s[20:23], s49 offen sc1
    s_add_u32 s49, s58, 786432
    buffer_load_dwordx4 v[152:155], v230, s[20:23], s49 offen sc1
    s_add_u32 s49, s58, 917504
    buffer_load_dwordx4 v[156:159], v230, s[20:23], s49 offen sc1
    s_add_u32 s48, s48, 1
    s_cmp_gt_u32 s48, 131072
    s_cbranch_scc1 L_end
    s_branch L_pc_17
L_pr_18:
    s_add_u32 s49, s58, 786432
    buffer_load_dwordx4 v[152:155], v230, s[20:23], s49 offen sc1
    s_add_u32 s49, s58, 917504
    buffer_load_dwordx4 v[156:159], v230, s[20:23], s49 offen sc1
    s_add_u32 s48, s48, 1
    s_cmp_gt_u32 s48, 131072
    s_cbranch_scc1 L_end
    s_branch L_pc_19
L_pr_20:
    s_add_u32 s49, s58, 917504
    buffer_load_dwordx4 v[156:159], v230, s[20:23], s49 offen sc1
    s_add_u32 s48, s48, 1
    s_cmp_gt_u32 s48, 131072
    s_cbranch_scc1 L_end
    s_branch L_pc_21
L_cs_22:
    buffer_store_dwordx2 v[32:33], v6, s[20:23], s6 offen sc1
    s_branch L_ce_23
L_wgt:
    s_load_dwordx2 s[4:5], s[0:1], 0
    s_load_dwordx2 s[32:33], s[0:1], 16
    s_load_dwordx2 s[20:21], s[0:1], 104
    s_load_dwordx2 s[8:9], s[0:1], 24
    s_load_dwordx2 s[28:29], s[0:1], 80
    s_mov_b32 s6, 1280
    s_mov_b32 s7, 0x20000
    s_mov_b32 s10, 4194304
    s_mov_b32 s11, 0x20000
    s_mov_b32 s34, 5242880
    s_mov_b32 s35, 0x20000
    s_mov_b32 s22, 7340032
    s_mov_b32 s23, 0x20000
    s_mov_b32 s30, 1280
    s_mov_b32 s31, 0x20000
    s_and_b32 s44, s2, 7
    s_lshr_b32 s45, s2, 3
    s_sub_u32 s45, s45, 16
    s_lshr_b32 s49, s45, 2
    s_lshl_b32 s46, s44, 2
    s_add_u32 s46, s46, s49
    s_and_b32 s47, s45, 3
    v_and_b32 v1, 15, v0
    v_lshrrev_b32 v2, 4, v0
    v_mul_u32_u24 v4, 80, v2
    s_mul_i32 s50, s47, 160
    s_mul_i32 s49, s3, 10
    s_add_u32 s50, s50, s49
    s_lshl_b32 s52, s50, 13
    s_lshl_b32 s50, s50, 1
    s_lshl_b32 s49, s46, 8
    s_add_u32 s52, s52, s49
    v_mul_u32_u24 v6, 40, v2
    v_bfe_u32 v3, v0, 3, 1
    v_add_u32 v6, v6, v3
    v_lshlrev_b32 v5, 13, v6
    v_and_b32 v3, 7, v0
    v_lshl_add_u32 v5, v3, 4, v5
    v_lshrrev_b32 v210, 2, v1
    v_lshlrev_b32 v14, 9, v210
    v_lshl_add_u32 v14, v2, 7, v14
    v_and_b32 v3, 3, v0
    v_lshl_add_u32 v14, v3, 4, v14
    s_lshl_b32 s54, s46, 11
    s_add_u32 s54, s54, 65536
    v_lshlrev_b32 v7, 4, v0
    s_and_b32 s51, s2, 3
    s_mul_i32 s53, s51, 160
    s_mul_i32 s49, s3, 10
    s_add_u32 s53, s53, s49
    s_lshl_b32 s6, s53, 1
    v_add_u32 v11, s6, v4
    s_mov_b32 s6, 1280
    s_waitcnt lgkmcnt(0)
    s_load_dword s40, s[20:21], 0
    buffer_load_dwordx4 v[224:227], v4, s[4:7], s50 offen
    buffer_load_dword v228, v4, s[4:7], s50 offen offset:16
    buffer_load_dword v48, v14, s[20:23], s54 offen sc1
    buffer_load_dwordx4 a[0:3], v5, s[32:35], s52 offen offset:0 nt
    buffer_load_dwordx4 a[4:7], v5, s[32:35], s52 offen offset:128 nt
    s_add_u32 s52, s52, 16384
    buffer_load_dwordx4 a[8:11], v5, s[32:35], s52 offen offset:0 nt
    buffer_load_dwordx4 a[12:15], v5, s[32:35], s52 offen offset:128 nt
    s_add_u32 s52, s52, 16384
    buffer_load_dwordx4 a[16:19], v5, s[32:35], s52 offen offset:0 nt
    buffer_load_dwordx4 a[20:23], v5, s[32:35], s52 offen offset:128 nt
    s_add_u32 s52, s52, 16384
    s_load_dwordx2 s[12:13], s[0:1], 32
    s_load_dwordx2 s[16:17], s[0:1], 40
    s_load_dwordx2 s[24:25], s[0:1], 72
    s_load_dwordx2 s[36:37], s[0:1], 64
    s_mov_b32 s14, 4194304
    s_mov_b32 s15, 0x20000
    s_mov_b32 s18, 5242880
    s_mov_b32 s19, 0x20000
    s_mov_b32 s26, 2211840
    s_mov_b32 s27, 0x20000
    s_mov_b32 s38, 2211840
    s_mov_b32 s39, 0x20000
    v_bfe_u32 v8, v0, 3, 1
    v_mul_u32_u24 v8, 0x0202, v8
    v_add_u32 v8, 0x0100, v8
    v_or_b32 v9, 0x0c0c0000, v8
    v_lshlrev_b32 v8, 16, v8
    v_or_b32 v8, 0x0c0c, v8
    v_and_b32 v10, 1, v0
    v_cmp_eq_u32 vcc, 1, v10
    v_bfe_u32 v10, v0, 1, 2
    v_mov_b32 v19, 0x0c0c0c0c
    v_cndmask_b32 v8, v9, v8, vcc
    v_cmp_eq_u32 vcc, 0, v10
    s_nop 1
    v_cndmask_b32 v16, v19, v8, vcc
    v_cmp_eq_u32 vcc, 1, v10
    s_nop 1
    v_cndmask_b32 v17, v19, v8, vcc
    v_cmp_eq_u32 vcc, 2, v10
    s_nop 1
    v_cndmask_b32 v18, v19, v8, vcc
    v_cmp_eq_u32 vcc, 3, v10
    s_nop 1
    v_cndmask_b32 v19, v19, v8, vcc
    s_lshl_b32 s63, s47, 2
    s_add_u32 s63, s63, s3
    s_lshl_b32 s55, s63, 6
    s_lshl_b32 s63, s63, 18
    s_lshl_b32 s49, s46, 8
    s_add_u32 s63, s63, s49
    s_lshl_b32 s49, s46, 10
    s_add_u32 s55, s55, s49
    s_add_u32 s55, s55, 131072
    s_lshl_b32 s62, s3, 13
    s_add_u32 s62, s62, 115712
    v_lshrrev_b32 v3, 5, v0
    v_xor_b32 v3, v1, v3
    v_lshlrev_b32 v3, 4, v3
    v_lshl_add_u32 v176, v2, 13, v3
    v_xor_b32 v3, v1, v2
    v_lshlrev_b32 v3, 4, v3
    v_lshl_add_u32 v3, v1, 9, v3
    v_add_u32 v20, s62, v3
    v_xor_b32 v21, 64, v20
    v_xor_b32 v22, 128, v20
    v_xor_b32 v23, 192, v20
    v_lshlrev_b32 v15, 2, v1
    v_and_b32 v3, 3, v1
    v_lshlrev_b32 v3, 1, v3
    v_bfe_u32 v9, v0, 4, 1
    v_add_u32 v3, v3, v9
    v_lshlrev_b32 v3, 2, v3
    v_bfe_u32 v9, v0, 2, 1
    v_add_u32 v3, v3, v9
    v_lshrrev_b32 v9, 5, v0
    v_lshl_add_u32 v3, v9, 1, v3
    v_lshlrev_b32 v12, 4, v3
    s_lshl_b32 s49, s47, 9
    s_add_u32 s56, s54, s49
    v_mov_b32 v24, 0x07060302
    v_mov_b32 v25, 0x00010001
    v_xor_b32 v177, 32, v176
    v_xor_b32 v178, 64, v176
    v_xor_b32 v179, 96, v176
    v_xor_b32 v180, 128, v176
    v_xor_b32 v181, 160, v176
    v_xor_b32 v182, 192, v176
    v_xor_b32 v183, 224, v176
    v_lshrrev_b32 v3, 1, v0
    v_lshlrev_b32 v56, 10, v3
    v_and_b32 v9, 1, v0
    v_mul_u32_u24 v3, 128, v9
    v_add_u32 v56, v56, v3
    v_lshrrev_b32 v3, 3, v0
    v_lshlrev_b32 v165, 13, v3
    v_and_b32 v3, 7, v0
    v_lshl_add_u32 v165, v3, 7, v165
    v_lshrrev_b32 v8, 5, v0
    v_mul_u32_u24 v57, 3456, v6
    v_and_b32 v3, 7, v0
    v_lshl_add_u32 v57, v3, 4, v57
    s_sub_u32 s50, s2, 128
    s_lshr_b32 s50, s50, 2
    s_mul_i32 s53, s53, 3456
    s_lshl_b32 s49, s50, 7
    s_add_u32 s53, s53, s49
    s_cmp_ge_u32 s50, 27
    s_cselect_b32 s57, 0x10000000, 0
    s_add_u32 s53, s53, s57
    v_mul_u32_u24 v44, 640, v8
    v_lshl_add_u32 v44, v9, 8, v44
    v_bfe_u32 v3, v0, 1, 3
    v_lshl_add_u32 v44, v3, 4, v44
    v_bfe_u32 v3, v0, 4, 1
    v_lshl_add_u32 v44, v3, 10, v44
    v_add_u32 v44, 106496, v44
    v_and_b32 v10, 31, v0
    v_lshlrev_b32 v10, 4, v10
    v_lshl_add_u32 v45, v8, 3, v10
    v_mov_b32 v218, 0xff
    s_lshl_b32 s49, s3, 11
    s_add_u32 s49, s49, 106496
    v_add_u32 v13, s49, v7
    v_bfe_u32 v10, v0, 1, 2
    v_xor_b32 v10, v2, v10
    v_lshlrev_b32 v10, 5, v10
    v_lshl_add_u32 v10, v9, 4, v10
    v_lshrrev_b32 v9, 3, v0
    v_mul_u32_u24 v30, 1280, v9
    v_add_u32 v30, v30, v10
    v_bfe_u32 v9, v0, 3, 1
    v_lshl_add_u32 v3, v9, 4, v3
    v_lshl_add_u32 v3, v8, 2, v3
    v_mul_u32_u24 v29, 1280, v3
    v_add_u32 v29, v29, v10
    s_lshl_b32 s58, s50, 2
    s_add_u32 s58, s58, s51
    s_mul_i32 s58, s58, 20480
    s_lshl_b32 s49, s3, 7
    s_add_u32 s58, s58, s49
    s_add_u32 s58, s58, s57
    s_lshl_b32 s59, s46, 2
    s_add_u32 s59, s59, s47
    s_mul_i32 s59, s59, 40960
    s_add_u32 s59, s59, s49
    s_add_u32 s59, s59, 0
    s_cmp_ge_u32 s3, 2
    s_cselect_b32 s60, 0x10000000, 0
    s_mul_i32 s61, s3, 6144
    s_add_u32 s61, s61, 49152
    s_mul_i32 s57, s3, 12288
    v_lshlrev_b32 v8, 4, v8
    v_lshlrev_b32 v3, 1, v1
    s_waitcnt lgkmcnt(0)
    s_add_u32 s40, s40, 0x01010101
    s_lshr_b32 s41, s40, 8
    s_lshr_b32 s42, s40, 16
    s_lshr_b32 s43, s40, 24
    v_mov_b32 v42, s40
    v_mov_b32 v43, s40
    v_lshrrev_b32 v3, v3, v42
    v_and_b32 v3, 3, v3
    v_lshl_or_b32 v26, v3, 15, v3
    v_not_b32 v3, v26
    v_and_b32 v28, 0x10000, v3
    v_lshlrev_b32 v3, 16, v3
    v_and_b32 v27, 0x10000, v3
    v_lshrrev_b32 v216, v8, v42
    v_lshrrev_b32 v217, 8, v216
    s_lshl_b32 s49, s3, 10
    s_add_u32 s49, s49, 106496
    v_add_u32 v31, s49, v7
    v_add_u32 v46, 106496, v7
    buffer_load_dwordx4 a[24:27], v5, s[32:35], s52 offen offset:0 nt
    buffer_load_dwordx4 a[28:31], v5, s[32:35], s52 offen offset:128 nt
    s_add_u32 s52, s52, 16384
    buffer_load_dwordx4 a[32:35], v5, s[32:35], s52 offen offset:0 nt
    buffer_load_dwordx4 a[36:39], v5, s[32:35], s52 offen offset:128 nt
    s_add_u32 s52, s52, 16384
    s_waitcnt vmcnt(11)
    v_perm_b32 v64, v224, v224, v16
    v_perm_b32 v65, v224, v224, v17
    v_perm_b32 v66, v224, v224, v18
    v_perm_b32 v67, v224, v224, v19
    v_perm_b32 v68, v225, v225, v16
    v_perm_b32 v69, v225, v225, v17
    v_perm_b32 v70, v225, v225, v18
    v_perm_b32 v71, v225, v225, v19
    v_perm_b32 v72, v226, v226, v16
    v_perm_b32 v73, v226, v226, v17
    v_perm_b32 v74, v226, v226, v18
    v_perm_b32 v75, v226, v226, v19
    v_perm_b32 v76, v227, v227, v16
    v_perm_b32 v77, v227, v227, v17
    v_perm_b32 v78, v227, v227, v18
    v_perm_b32 v79, v227, v227, v19
    v_perm_b32 v80, v228, v228, v16
    v_perm_b32 v81, v228, v228, v17
    v_perm_b32 v82, v228, v228, v18
    v_perm_b32 v83, v228, v228, v19
    s_waitcnt vmcnt(9)
    v_mfma_f32_16x16x32_bf16 v[32:35], v[64:67], a[0:3], 0
    s_waitcnt vmcnt(8)
    v_mfma_f32_16x16x32_bf16 v[36:39], v[64:67], a[4:7], 0
    s_waitcnt vmcnt(7)
    v_mfma_f32_16x16x32_bf16 v[32:35], v[68:71], a[8:11], v[32:35]
    s_waitcnt vmcnt(6)
    v_mfma_f32_16x16x32_bf16 v[36:39], v[68:71], a[12:15], v[36:39]
    s_waitcnt vmcnt(5)
    v_mfma_f32_16x16x32_bf16 v[32:35], v[72:75], a[16:19], v[32:35]
    s_waitcnt vmcnt(4)
    v_mfma_f32_16x16x32_bf16 v[36:39], v[72:75], a[20:23], v[36:39]
    s_waitcnt vmcnt(3)
    v_mfma_f32_16x16x32_bf16 v[32:35], v[76:79], a[24:27], v[32:35]
    s_waitcnt vmcnt(2)
    v_mfma_f32_16x16x32_bf16 v[36:39], v[76:79], a[28:31], v[36:39]
    s_waitcnt vmcnt(1)
    v_mfma_f32_16x16x32_bf16 v[32:35], v[80:83], a[32:35], v[32:35]
    s_waitcnt vmcnt(0)
    v_mfma_f32_16x16x32_bf16 v[36:39], v[80:83], a[36:39], v[36:39]
    s_nop 7
    v_permlane32_swap_b32 v32, v36
    v_permlane32_swap_b32 v33, v37
    v_permlane32_swap_b32 v34, v38
    v_permlane32_swap_b32 v35, v39
    v_add_f32_dpp v32, v36, v32 row_ror:8 row_mask:0xf bank_mask:0xf
    v_add_f32_dpp v33, v37, v33 row_ror:8 row_mask:0xf bank_mask:0xf
    v_add_f32_dpp v34, v38, v34 row_ror:8 row_mask:0xf bank_mask:0xf
    v_add_f32_dpp v35, v39, v35 row_ror:8 row_mask:0xf bank_mask:0xf
    ds_write_b128 v31, v[32:35]
    s_waitcnt lgkmcnt(0)
    s_barrier
    s_cmp_lg_u32 s3, 0
    s_cbranch_scc1 L_now1_25
    ds_read_b128 v[36:39], v46 offset:1024
    ds_read_b128 v[64:67], v46 offset:2048
    ds_read_b128 v[68:71], v46 offset:3072
    s_mov_b32 exec_lo, 0x00ff00ff
    s_mov_b32 exec_hi, 0x00ff00ff
    s_waitcnt lgkmcnt(2)
    v_pk_add_f32 v[32:33], v[32:33], v[36:37]
    v_pk_add_f32 v[34:35], v[34:35], v[38:39]
    s_waitcnt lgkmcnt(0)
    v_pk_add_f32 v[64:65], v[64:65], v[68:69]
    v_pk_add_f32 v[66:67], v[66:67], v[70:71]
    v_pk_add_f32 v[32:33], v[32:33], v[64:65]
    v_pk_add_f32 v[34:35], v[34:35], v[66:67]
    v_cvt_pk_bf16_f32 v40, v32, v33
    v_cvt_pk_bf16_f32 v41, v34, v35
    buffer_store_dwordx4 v[40:43], v12, s[20:23], s56 offen
    s_mov_b64 exec, -1
L_now1_25:
    s_barrier
    s_add_u32 m0, s62, 0
    s_add_u32 s49, s63, 0
    buffer_load_dwordx4 v176, s[8:11], s49 offen nt lds
    s_add_u32 m0, s62, 1024
    s_add_u32 s49, s63, 32768
    buffer_load_dwordx4 v177, s[8:11], s49 offen nt lds
    s_add_u32 m0, s62, 2048
    s_add_u32 s49, s63, 65536
    buffer_load_dwordx4 v178, s[8:11], s49 offen nt lds
    s_add_u32 m0, s62, 3072
    s_add_u32 s49, s63, 98304
    buffer_load_dwordx4 v179, s[8:11], s49 offen nt lds
    s_add_u32 m0, s62, 4096
    s_add_u32 s49, s63, 131072
    buffer_load_dwordx4 v180, s[8:11], s49 offen nt lds
    s_add_u32 m0, s62, 5120
    s_add_u32 s49, s63, 163840
    buffer_load_dwordx4 v181, s[8:11], s49 offen nt lds
    s_add_u32 m0, s62, 6144
    s_add_u32 s49, s63, 196608
    buffer_load_dwordx4 v182, s[8:11], s49 offen nt lds
    s_add_u32 m0, s62, 7168
    s_add_u32 s49, s63, 229376
    buffer_load_dwordx4 v183, s[8:11], s49 offen nt lds
    s_mov_b32 s48, 0
    buffer_load_dwordx4 v[48:51], v14, s[20:23], s54 offen sc1
    buffer_load_dwordx4 v[52:55], v14, s[20:23], s54 offen offset:64 sc1
    s_load_dwordx2 s[32:33], s[0:1], 8
    s_mov_b32 s34, 16777216
    s_lshl_b32 s52, s44, 4
    s_add_u32 s52, s52, s45
    s_lshl_b32 s52, s52, 2
    s_add_u32 s52, s52, s3
    s_lshl_b32 s52, s52, 15
    s_mul_i32 s49, s3, 256
    s_add_u32 s52, s52, s49
    s_lshl_b32 s62, s47, 1
    s_lshr_b32 s49, s3, 1
    s_add_u32 s62, s62, s49
    s_lshl_b32 s62, s62, 3
    s_lshr_b32 s49, s45, 2
    s_lshl_b32 s49, s49, 1
    s_add_u32 s62, s62, s49
    s_and_b32 s49, s3, 1
    s_add_u32 s62, s62, s49
    s_lshl_b32 s62, s62, 16
    s_lshl_b32 s49, s44, 10
    s_add_u32 s62, s62, s49
    s_waitcnt vmcnt(2)
    ds_read_b128 v[184:187], v20 offset:0
    ds_read_b128 v[188:191], v21 offset:0
    ds_read_b128 v[192:195], v22 offset:0
    ds_read_b128 v[196:199], v23 offset:0
    ds_read_b128 v[200:203], v20 offset:256
    ds_read_b128 v[204:207], v21 offset:256
    ds_read_b128 v[208:211], v22 offset:256
    ds_read_b128 v[212:215], v23 offset:256
L_qp_26:
    s_waitcnt vmcnt(0)
    v_xor_b32 v3, s40, v50
    v_bitop3_b32 v3, v3, v54, s40 bitop3:0xf6
    v_cmp_ne_u32 vcc, 0, v3
    s_cbranch_vccz L_qps_27
    buffer_load_dwordx4 v[48:51], v14, s[20:23], s54 offen sc1
    buffer_load_dwordx4 v[52:55], v14, s[20:23], s54 offen offset:64 sc1
    s_add_u32 s48, s48, 1
    s_cmp_gt_u32 s48, 131072
    s_cbranch_scc1 L_end
    s_cmp_lg_u32 s48, 24
    s_cbranch_scc1 L_qp_26
    s_add_u32 s54, s54, 720896
    s_cmp_lg_u32 s3, 0
    s_cbranch_scc1 L_qp_26
    s_mov_b32 exec_lo, 0x00ff00ff
    s_mov_b32 exec_hi, 0x00ff00ff
    s_add_u32 s49, s56, 720896
    buffer_store_dwordx4 v[40:43], v12, s[20:23], s49 offen sc1
    s_mov_b64 exec, -1
    s_branch L_qp_26
L_qps_27:
    v_mov_b32_dpp v64, v48 quad_perm:[0,0,0,0] row_mask:0xf bank_mask:0xf
    v_mov_b32_dpp v65, v49 quad_perm:[0,0,0,0] row_mask:0xf bank_mask:0xf
    v_mov_b32_dpp v66, v52 quad_perm:[0,0,0,0] row_mask:0xf bank_mask:0xf
    v_mov_b32_dpp v67, v53 quad_perm:[0,0,0,0] row_mask:0xf bank_mask:0xf
    v_mov_b32_dpp v68, v48 quad_perm:[1,1,1,1] row_mask:0xf bank_mask:0xf
    v_mov_b32_dpp v69, v49 quad_perm:[1,1,1,1] row_mask:0xf bank_mask:0xf
    v_mov_b32_dpp v70, v52 quad_perm:[1,1,1,1] row_mask:0xf bank_mask:0xf
    v_mov_b32_dpp v71, v53 quad_perm:[1,1,1,1] row_mask:0xf bank_mask:0xf
    s_waitcnt lgkmcnt(0)
    v_mfma_f32_16x16x32_bf16 v[32:35], v[64:67], v[184:187], 0
    v_mfma_f32_16x16x32_bf16 v[36:39], v[64:67], v[200:203], 0
    v_mov_b32_dpp v72, v48 quad_perm:[2,2,2,2] row_mask:0xf bank_mask:0xf
    v_mov_b32_dpp v73, v49 quad_perm:[2,2,2,2] row_mask:0xf bank_mask:0xf
    v_mov_b32_dpp v74, v52 quad_perm:[2,2,2,2] row_mask:0xf bank_mask:0xf
    v_mov_b32_dpp v75, v53 quad_perm:[2,2,2,2] row_mask:0xf bank_mask:0xf
    v_mfma_f32_16x16x32_bf16 v[32:35], v[68:71], v[188:191], v[32:35]
    v_mfma_f32_16x16x32_bf16 v[36:39], v[68:71], v[204:207], v[36:39]
    v_mov_b32_dpp v76, v48 quad_perm:[3,3,3,3] row_mask:0xf bank_mask:0xf
    v_mov_b32_dpp v77, v49 quad_perm:[3,3,3,3] row_mask:0xf bank_mask:0xf
    v_mov_b32_dpp v78, v52 quad_perm:[3,3,3,3] row_mask:0xf bank_mask:0xf
    v_mov_b32_dpp v79, v53 quad_perm:[3,3,3,3] row_mask:0xf bank_mask:0xf
    v_mfma_f32_16x16x32_bf16 v[32:35], v[72:75], v[192:195], v[32:35]
    v_mfma_f32_16x16x32_bf16 v[36:39], v[72:75], v[208:211], v[36:39]
    v_mfma_f32_16x16x32_bf16 v[32:35], v[76:79], v[196:199], v[32:35]
    v_mfma_f32_16x16x32_bf16 v[36:39], v[76:79], v[212:215], v[36:39]
    s_nop 7
    v_permlane32_swap_b32 v32, v36
    v_add_f32 v32, v32, v36
    v_mov_b32 v33, v32
    s_nop 1
    v_permlane16_swap_b32 v32, v33
    v_add_f32 v32, v32, v33
    v_mov_b32 v33, v32
    s_nop 1
    v_permlane32_swap_b32 v32, v33
    v_add_u32 v32, v32, v27
    v_add_u32 v33, v33, v28
    v_perm_b32 v32, v33, v32, v24
    v_bfi_b32 v32, v25, v26, v32
    s_mov_b64 exec, 0xffff
    buffer_store_dword v32, v15, s[20:23], s55 offen sc1
    s_mov_b64 exec, -1
    s_cmp_lg_u32 s3, 0
    s_cbranch_scc1 L_qwt_28
    s_mov_b32 exec_lo, 0x00ff00ff
    s_mov_b32 exec_hi, 0x00ff00ff
    s_add_u32 s49, s56, 720896
    buffer_store_dwordx4 v[40:43], v12, s[20:23], s49 offen sc1
    s_mov_b64 exec, -1
L_qwt_28:
    s_barrier
    s_getreg_b32 s56, hwreg(HW_REG_XCC_ID, 0, 4)
    s_cmp_lg_u32 s3, 1
    s_cbranch_scc1 L_xc_29
    v_mov_b32 v4, s56
    v_mov_b32 v5, s40
    v_mov_b32 v3, 0
    s_lshl_b32 s49, s44, 8
    s_and_b32 m0, s2, 0xf8
    s_add_u32 s49, s49, m0
    s_add_u32 s49, s49, 4096
    s_mov_b64 exec, 1
    buffer_store_dwordx2 v[4:5], v3, s[20:23], s49 offen sc1
    s_mov_b64 exec, -1
L_xc_29:
    buffer_load_dwordx4 v[160:163], v11, s[4:7], 0 offen
    buffer_load_dword v164, v11, s[4:7], 0 offen offset:16
    buffer_load_dwordx4 v[144:147], v7, s[4:7], 0 offen
    buffer_load_dwordx4 v[148:151], v7, s[4:7], 0 offen offset:1024
    buffer_load_dwordx4 v[152:155], v7, s[28:31], 0 offen
    buffer_load_dwordx4 v[156:159], v7, s[28:31], 0 offen offset:1024
    s_load_dwordx2 s[28:29], s[0:1], 56
    s_mov_b32 s30, 2211840
    s_xor_b32 s49, s52, 512
    buffer_load_dword v58, v56, s[32:35], s49 offen
    v_bfe_u32 v3, v0, 2, 3
    v_lshlrev_b32 v4, 7, v3
    v_lshrrev_b32 v3, 1, v3
    v_lshl_add_u32 v4, v3, 5, v4
    v_and_b32 v3, 3, v0
    v_lshl_add_u32 v4, v3, 3, v4
    v_lshrrev_b32 v3, 5, v0
    v_lshl_add_u32 v4, v3, 10, v4
    v_xor_b32 v3, 0, v4
    v_add_u32 v244, s57, v3
    v_add_u32 v248, s61, v3
    v_xor_b32 v3, 32, v4
    v_add_u32 v245, s57, v3
    v_add_u32 v249, s61, v3
    v_xor_b32 v3, 64, v4
    v_add_u32 v246, s57, v3
    v_add_u32 v250, s61, v3
    v_xor_b32 v3, 96, v4
    v_add_u32 v247, s57, v3
    v_add_u32 v251, s61, v3
    v_lshrrev_b32 v210, 2, v1
    v_lshlrev_b32 v14, 9, v210
    v_lshl_add_u32 v14, v2, 4, v14
    v_lshlrev_b32 v211, 10, v2
    v_lshl_add_u32 v211, v1, 4, v211
    v_lshlrev_b32 v15, 4, v1
    v_lshl_add_u32 v15, v2, 9, v15
    v_lshlrev_b32 v20, 7, v1
    s_lshl_b32 s55, s46, 2
    s_add_u32 s55, s55, s47
    s_lshl_b32 s55, s55, 11
    s_add_u32 s55, s55, 1048576
    s_lshl_b32 s5, s50, 11
    s_add_u32 s5, s5, 262144
    s_lshl_b32 s49, s51, 9
    s_add_u32 s54, s5, s49
    s_lshl_b32 s49, s51, 6
    s_add_u32 s5, s5, s49
    s_waitcnt lgkmcnt(0)
    s_xor_b32 s49, s52, 768
    buffer_load_dword v59, v56, s[32:35], s49 offen
    buffer_load_dwordx4 a[0:3], v57, s[28:31], s53 offen nt
    buffer_load_dwordx4 a[4:7], v57, s[36:39], s53 offen nt
    s_add_u32 s53, s53, 6912
    buffer_load_dwordx4 a[8:11], v57, s[28:31], s53 offen nt
    buffer_load_dwordx4 a[12:15], v57, s[36:39], s53 offen nt
    s_add_u32 s53, s53, 6912
    buffer_load_dwordx4 a[16:19], v57, s[28:31], s53 offen nt
    buffer_load_dwordx4 a[20:23], v57, s[36:39], s53 offen nt
    s_add_u32 s53, s53, 6912
    buffer_load_dwordx4 a[24:27], v57, s[28:31], s53 offen nt
    buffer_load_dwordx4 a[28:31], v57, s[36:39], s53 offen nt
    s_add_u32 s53, s53, 6912
    buffer_load_dwordx4 a[32:35], v57, s[28:31], s53 offen nt
    buffer_load_dwordx4 a[36:39], v57, s[36:39], s53 offen nt
    s_add_u32 s53, s53, 6912
    buffer_load_dword v60, v165, s[12:15], s62 offen
    s_add_u32 m0, s61, 0
    s_add_u32 s49, s58, 0
    buffer_load_dwordx4 v30, s[24:27], s49 offen nt lds
    s_add_u32 m0, s61, 1024
    s_add_u32 s49, s58, 10240
    buffer_load_dwordx4 v30, s[24:27], s49 offen nt lds
    s_waitcnt vmcnt(15)
    v_perm_b32 v64, v160, v160, v16
    v_perm_b32 v65, v160, v160, v17
    v_perm_b32 v66, v160, v160, v18
    v_perm_b32 v67, v160, v160, v19
    v_perm_b32 v68, v161, v161, v16
    v_perm_b32 v69, v161, v161, v17
    v_perm_b32 v70, v161, v161, v18
    v_perm_b32 v71, v161, v161, v19
    v_perm_b32 v72, v162, v162, v16
    v_perm_b32 v73, v162, v162, v17
    v_perm_b32 v74, v162, v162, v18
    v_perm_b32 v75, v162, v162, v19
    v_perm_b32 v76, v163, v163, v16
    v_perm_b32 v77, v163, v163, v17
    v_perm_b32 v78, v163, v163, v18
    v_perm_b32 v79, v163, v163, v19
    v_perm_b32 v80, v164, v164, v16
    v_perm_b32 v81, v164, v164, v17
    v_perm_b32 v82, v164, v164, v18
    v_perm_b32 v83, v164, v164, v19
    v_dot2_f32_bf16 v3, v144, v152, 0
    v_dot2_f32_bf16 v3, v145, v153, v3
    v_dot2_f32_bf16 v3, v146, v154, v3
    v_dot2_f32_bf16 v3, v147, v155, v3
    v_dot2_f32_bf16 v3, v148, v156, v3
    v_dot2_f32_bf16 v3, v149, v157, v3
    v_dot2_f32_bf16 v3, v150, v158, v3
    v_dot2_f32_bf16 v3, v151, v159, v3
    s_nop 2
    v_add_f32_dpp v3, v3, v3 row_ror:8 row_mask:0xf bank_mask:0xf
    s_nop 1
    v_add_f32_dpp v3, v3, v3 row_ror:4 row_mask:0xf bank_mask:0xf
    s_nop 1
    v_add_f32_dpp v3, v3, v3 row_ror:2 row_mask:0xf bank_mask:0xf
    s_nop 1
    v_add_f32_dpp v3, v3, v3 row_ror:1 row_mask:0xf bank_mask:0xf
    s_nop 1
    v_mov_b32 v4, v3
    s_nop 1
    v_permlane16_swap_b32 v3, v4
    v_add_f32 v3, v3, v4
    v_mov_b32 v4, v3
    s_nop 1
    v_permlane32_swap_b32 v3, v4
    v_add_f32 v3, v3, v4
    v_mul_f32 v3, 0xbfb8aa3b, v3
    v_exp_f32 v3, v3
    s_nop 0
    v_add_f32 v3, 1.0, v3
    v_rcp_f32 v220, v3
    s_nop 0
    v_sub_f32 v221, 1.0, v220
    s_waitcnt vmcnt(12)
    v_mfma_f32_16x16x32_bf16 v[32:35], v[64:67], a[0:3], 0
    s_waitcnt vmcnt(11)
    v_mfma_f32_16x16x32_bf16 v[36:39], v[64:67], a[4:7], 0
    s_waitcnt vmcnt(10)
    v_mfma_f32_16x16x32_bf16 v[32:35], v[68:71], a[8:11], v[32:35]
    s_waitcnt vmcnt(9)
    v_mfma_f32_16x16x32_bf16 v[36:39], v[68:71], a[12:15], v[36:39]
    s_waitcnt vmcnt(8)
    v_mfma_f32_16x16x32_bf16 v[32:35], v[72:75], a[16:19], v[32:35]
    s_waitcnt vmcnt(7)
    v_mfma_f32_16x16x32_bf16 v[36:39], v[72:75], a[20:23], v[36:39]
    s_waitcnt vmcnt(6)
    v_mfma_f32_16x16x32_bf16 v[32:35], v[76:79], a[24:27], v[32:35]
    s_waitcnt vmcnt(5)
    v_mfma_f32_16x16x32_bf16 v[36:39], v[76:79], a[28:31], v[36:39]
    s_waitcnt vmcnt(4)
    v_mfma_f32_16x16x32_bf16 v[32:35], v[80:83], a[32:35], v[32:35]
    s_waitcnt vmcnt(3)
    v_mfma_f32_16x16x32_bf16 v[36:39], v[80:83], a[36:39], v[36:39]
    s_nop 7
    ds_write_b128 v13, v[32:35]
    ds_write_b128 v13, v[36:39] offset:1024
    s_waitcnt lgkmcnt(0)
    s_barrier
    s_cmp_lg_u32 s3, 3
    s_cbranch_scc1 L_skip_30
    ds_read_b128 v[128:131], v44 offset:0
    ds_read_b128 v[132:135], v44 offset:2048
    ds_read_b128 v[136:139], v44 offset:4096
    ds_read_b128 v[140:143], v44 offset:6144
    s_waitcnt lgkmcnt(2)
    v_add_f32 v128, v128, v132
    v_add_f32 v129, v129, v133
    v_add_f32 v130, v130, v134
    v_add_f32 v131, v131, v135
    s_waitcnt lgkmcnt(0)
    v_add_f32 v136, v136, v140
    v_add_f32 v137, v137, v141
    v_add_f32 v138, v138, v142
    v_add_f32 v139, v139, v143
    v_add_f32 v128, v128, v136
    v_add_f32 v129, v129, v137
    v_add_f32 v130, v130, v138
    v_add_f32 v131, v131, v139
    s_nop 0
    v_permlane32_swap_b32 v128, v130
    v_permlane32_swap_b32 v129, v131
    v_add_f32 v128, v128, v130
    v_add_f32 v129, v129, v131
    v_bfi_b32 v128, v218, v216, v128
    v_bfi_b32 v129, v218, v217, v129
    buffer_store_dwordx2 v[128:129], v45, s[20:23], s54 offen sc1
L_skip_30:
    s_add_u32 m0, s61, 2048
    s_add_u32 s49, s58, 512
    buffer_load_dwordx4 v30, s[24:27], s49 offen nt lds
    s_add_u32 m0, s61, 3072
    s_add_u32 s49, s58, 10752
    buffer_load_dwordx4 v30, s[24:27], s49 offen nt lds
    s_add_u32 m0, s61, 4096
    s_add_u32 s49, s58, 1024
    s_add_u32 s49, s49, s60
    buffer_load_dwordx4 v30, s[24:27], s49 offen nt lds
    s_add_u32 m0, s61, 5120
    s_add_u32 s49, s58, 11264
    s_add_u32 s49, s49, s60
    buffer_load_dwordx4 v30, s[24:27], s49 offen nt lds
    s_add_u32 m0, s57, 0
    s_add_u32 s49, s59, 0
    buffer_load_dwordx4 v29, s[16:19], s49 offen nt lds
    s_add_u32 m0, s57, 1024
    s_add_u32 s49, s59, 10240
    buffer_load_dwordx4 v29, s[16:19], s49 offen nt lds
    s_add_u32 m0, s57, 2048
    s_add_u32 s49, s59, 2560
    buffer_load_dwordx4 v29, s[16:19], s49 offen nt lds
    s_add_u32 m0, s57, 3072
    s_add_u32 s49, s59, 12800
    buffer_load_dwordx4 v29, s[16:19], s49 offen nt lds
    s_add_u32 m0, s57, 4096
    s_add_u32 s49, s59, 512
    buffer_load_dwordx4 v29, s[16:19], s49 offen nt lds
    s_add_u32 m0, s57, 5120
    s_add_u32 s49, s59, 10752
    buffer_load_dwordx4 v29, s[16:19], s49 offen nt lds
    s_add_u32 m0, s57, 6144
    s_add_u32 s49, s59, 3072
    buffer_load_dwordx4 v29, s[16:19], s49 offen nt lds
    s_add_u32 m0, s57, 7168
    s_add_u32 s49, s59, 13312
    buffer_load_dwordx4 v29, s[16:19], s49 offen nt lds
    s_add_u32 m0, s57, 8192
    s_add_u32 s49, s59, 1024
    s_add_u32 s49, s49, s60
    buffer_load_dwordx4 v29, s[16:19], s49 offen nt lds
    s_add_u32 m0, s57, 9216
    s_add_u32 s49, s59, 11264
    s_add_u32 s49, s49, s60
    buffer_load_dwordx4 v29, s[16:19], s49 offen nt lds
    buffer_load_dword v21, v20, s[20:23], s55 offen sc1
    buffer_load_dwordx4 v[48:51], v14, s[20:23], s5 offen sc1
    buffer_load_dwordx4 v[52:55], v14, s[20:23], s5 offen offset:256 sc1
    s_add_u32 m0, s57, 10240
    s_add_u32 s49, s59, 3584
    s_add_u32 s49, s49, s60
    buffer_load_dwordx4 v29, s[16:19], s49 offen nt lds
    s_add_u32 m0, s57, 11264
    s_add_u32 s49, s59, 13824
    s_add_u32 s49, s49, s60
    buffer_load_dwordx4 v29, s[16:19], s49 offen nt lds
    s_lshl_b32 s4, s44, 4
    s_add_u32 s4, s4, s45
    s_mul_i32 s4, s4, 2560
    s_lshl_b32 s49, s3, 8
    s_add_u32 s4, s4, s49
    s_add_u32 s4, s4, 327680
    v_cmp_eq_u32 s[50:51], 0, v210
    v_cmp_eq_u32 s[52:53], 1, v210
    v_cmp_eq_u32 s[58:59], 2, v210
    s_cmp_ge_u32 s3, 2
    s_cselect_b32 s61, 0, 0xffff
    s_mov_b32 s48, 0
    s_waitcnt vmcnt(2)
    ds_read_b64_tr_b16 a[0:1], v248 offset:0
    ds_read_b64_tr_b16 a[2:3], v249 offset:0
    ds_read_b64_tr_b16 a[4:5], v250 offset:0
    ds_read_b64_tr_b16 a[6:7], v251 offset:0
    ds_read_b64_tr_b16 a[8:9], v248 offset:2048
    ds_read_b64_tr_b16 a[10:11], v249 offset:2048
    ds_read_b64_tr_b16 a[12:13], v250 offset:2048
    ds_read_b64_tr_b16 a[14:15], v251 offset:2048
    ds_read_b64_tr_b16 a[16:17], v248 offset:4096
    ds_read_b64_tr_b16 a[18:19], v249 offset:4096
    ds_read_b64_tr_b16 a[20:21], v250 offset:4096
    ds_read_b64_tr_b16 a[22:23], v251 offset:4096
L_fp_31:
    v_xor_b32 v3, s40, v48
    v_bitop3_b32 v3, v3, v49, s41 bitop3:0xf6
    v_bitop3_b32 v3, v3, v50, s42 bitop3:0xf6
    v_bitop3_b32 v3, v3, v51, s43 bitop3:0xf6
    v_bitop3_b32 v3, v3, v52, s40 bitop3:0xf6
    v_bitop3_b32 v3, v3, v53, s41 bitop3:0xf6
    v_bitop3_b32 v3, v3, v54, s42 bitop3:0xf6
    v_bitop3_b32 v3, v3, v55, s43 bitop3:0xf6
    v_and_b32 v3, 0xff, v3
    v_cmp_ne_u32 vcc, 0, v3
    s_cbranch_vccz L_fpok_32
    buffer_load_dwordx4 v[48:51], v14, s[20:23], s5 offen sc1
    buffer_load_dwordx4 v[52:55], v14, s[20:23], s5 offen offset:256 sc1
    s_add_u32 s48, s48, 1
    s_cmp_gt_u32 s48, 131072
    s_cbranch_scc1 L_end
    s_waitcnt vmcnt(0)
    s_branch L_fp_31
L_fpok_32:
    v_add_f32_dpp v48, v48, v48 row_ror:4 row_mask:0xf bank_mask:0xf
    v_add_f32_dpp v49, v49, v49 row_ror:4 row_mask:0xf bank_mask:0xf
    v_add_f32_dpp v50, v50, v50 row_ror:4 row_mask:0xf bank_mask:0xf
    v_add_f32_dpp v51, v51, v51 row_ror:4 row_mask:0xf bank_mask:0xf
    v_add_f32_dpp v52, v52, v52 row_ror:4 row_mask:0xf bank_mask:0xf
    v_add_f32_dpp v53, v53, v53 row_ror:4 row_mask:0xf bank_mask:0xf
    v_add_f32_dpp v54, v54, v54 row_ror:4 row_mask:0xf bank_mask:0xf
    v_add_f32_dpp v55, v55, v55 row_ror:4 row_mask:0xf bank_mask:0xf
    v_add_f32_dpp v48, v48, v48 row_ror:8 row_mask:0xf bank_mask:0xf
    v_add_f32_dpp v49, v49, v49 row_ror:8 row_mask:0xf bank_mask:0xf
    v_add_f32_dpp v50, v50, v50 row_ror:8 row_mask:0xf bank_mask:0xf
    v_add_f32_dpp v51, v51, v51 row_ror:8 row_mask:0xf bank_mask:0xf
    v_add_f32_dpp v52, v52, v52 row_ror:8 row_mask:0xf bank_mask:0xf
    v_add_f32_dpp v53, v53, v53 row_ror:8 row_mask:0xf bank_mask:0xf
    v_add_f32_dpp v54, v54, v54 row_ror:8 row_mask:0xf bank_mask:0xf
    v_add_f32_dpp v55, v55, v55 row_ror:8 row_mask:0xf bank_mask:0xf
    v_cvt_pk_bf16_f32 v32, v48, v52
    v_cvt_pk_bf16_f32 v33, v49, v53
    v_cvt_pk_bf16_f32 v34, v50, v54
    v_cvt_pk_bf16_f32 v35, v51, v55
    v_lshlrev_b32 v24, 16, v32
    v_and_b32 v28, 0xffff0000, v32
    v_lshlrev_b32 v25, 16, v33
    v_and_b32 v29, 0xffff0000, v33
    v_lshlrev_b32 v26, 16, v34
    v_and_b32 v30, 0xffff0000, v34
    v_lshlrev_b32 v27, 16, v35
    v_and_b32 v31, 0xffff0000, v35
    s_mov_b32 s49, 0xbdd2d3e8
    v_mov_b32 v3, 0xc0135761
    v_mul_f32 v32, v24, v24
    v_mul_f32 v33, v25, v25
    v_mul_f32 v34, v26, v26
    v_mul_f32 v35, v27, v27
    v_fma_f32 v32, v32, s49, v3
    v_fma_f32 v33, v33, s49, v3
    v_fma_f32 v34, v34, s49, v3
    v_fma_f32 v35, v35, s49, v3
    v_mul_f32 v32, v32, v24
    v_mul_f32 v33, v33, v25
    v_mul_f32 v34, v34, v26
    v_mul_f32 v35, v35, v27
    v_exp_f32 v32, v32
    v_exp_f32 v33, v33
    v_exp_f32 v34, v34
    v_exp_f32 v35, v35
    v_add_f32 v32, 1.0, v32
    v_add_f32 v33, 1.0, v33
    v_add_f32 v34, 1.0, v34
    v_add_f32 v35, 1.0, v35
    v_rcp_f32 v32, v32
    v_rcp_f32 v33, v33
    v_rcp_f32 v34, v34
    v_rcp_f32 v35, v35
    v_mul_f32 v32, v32, v24
    v_mul_f32 v33, v33, v25
    v_mul_f32 v34, v34, v26
    v_mul_f32 v35, v35, v27
    v_cvt_pk_bf16_f32 v32, v32, v32
    v_cvt_pk_bf16_f32 v33, v33, v33
    v_cvt_pk_bf16_f32 v34, v34, v34
    v_cvt_pk_bf16_f32 v35, v35, v35
    v_and_b32 v32, 0xffff0000, v32
    v_mul_f32 v32, v32, v28
    v_and_b32 v33, 0xffff0000, v33
    v_mul_f32 v33, v33, v29
    v_and_b32 v34, 0xffff0000, v34
    v_mul_f32 v34, v34, v30
    v_and_b32 v35, 0xffff0000, v35
    v_mul_f32 v35, v35, v31
    v_cvt_pk_bf16_f32 v24, v32, v33
    v_cvt_pk_bf16_f32 v25, v34, v35
    v_cmp_eq_u32 vcc, 0, v1
    s_nop 1
    v_cndmask_b32 v26, 0, v24, vcc
    v_cndmask_b32 v27, 0, v25, vcc
    v_cmp_eq_u32 vcc, 4, v1
    s_nop 1
    v_cndmask_b32 v28, 0, v24, vcc
    v_cndmask_b32 v29, 0, v25, vcc
    v_cmp_eq_u32 vcc, 8, v1
    s_nop 1
    v_cndmask_b32 v30, 0, v24, vcc
    v_cndmask_b32 v31, 0, v25, vcc
    s_waitcnt lgkmcnt(0)
    v_mfma_f32_16x16x16_bf16 v[176:179], v[26:27], a[0:1], 0
    v_mfma_f32_16x16x16_bf16 v[180:183], v[26:27], a[2:3], 0
    v_mfma_f32_16x16x16_bf16 v[184:187], v[26:27], a[4:5], 0
    v_mfma_f32_16x16x16_bf16 v[188:191], v[26:27], a[6:7], 0
    v_mfma_f32_16x16x16_bf16 v[176:179], v[28:29], a[8:9], v[176:179]
    v_mfma_f32_16x16x16_bf16 v[180:183], v[28:29], a[10:11], v[180:183]
    v_mfma_f32_16x16x16_bf16 v[184:187], v[28:29], a[12:13], v[184:187]
    v_mfma_f32_16x16x16_bf16 v[188:191], v[28:29], a[14:15], v[188:191]
    v_mfma_f32_16x16x16_bf16 v[176:179], v[30:31], a[16:17], v[176:179]
    v_mfma_f32_16x16x16_bf16 v[180:183], v[30:31], a[18:19], v[180:183]
    v_mfma_f32_16x16x16_bf16 v[184:187], v[30:31], a[20:21], v[184:187]
    v_mfma_f32_16x16x16_bf16 v[188:191], v[30:31], a[22:23], v[188:191]
    s_waitcnt vmcnt(0)
    ds_read_b64_tr_b16 a[24:25], v244 offset:0
    ds_read_b64_tr_b16 a[28:29], v245 offset:0
    ds_read_b64_tr_b16 a[32:33], v246 offset:0
    ds_read_b64_tr_b16 a[36:37], v247 offset:0
    ds_read_b64_tr_b16 a[26:27], v244 offset:2048
    ds_read_b64_tr_b16 a[30:31], v245 offset:2048
    ds_read_b64_tr_b16 a[34:35], v246 offset:2048
    ds_read_b64_tr_b16 a[38:39], v247 offset:2048
    ds_read_b64_tr_b16 a[40:41], v244 offset:4096
    ds_read_b64_tr_b16 a[44:45], v245 offset:4096
    ds_read_b64_tr_b16 a[48:49], v246 offset:4096
    ds_read_b64_tr_b16 a[52:53], v247 offset:4096
    ds_read_b64_tr_b16 a[42:43], v244 offset:6144
    ds_read_b64_tr_b16 a[46:47], v245 offset:6144
    ds_read_b64_tr_b16 a[50:51], v246 offset:6144
    ds_read_b64_tr_b16 a[54:55], v247 offset:6144
    ds_read_b64_tr_b16 a[56:57], v244 offset:8192
    ds_read_b64_tr_b16 a[60:61], v245 offset:8192
    ds_read_b64_tr_b16 a[64:65], v246 offset:8192
    ds_read_b64_tr_b16 a[68:69], v247 offset:8192
    ds_read_b64_tr_b16 a[58:59], v244 offset:10240
    ds_read_b64_tr_b16 a[62:63], v245 offset:10240
    ds_read_b64_tr_b16 a[66:67], v246 offset:10240
    ds_read_b64_tr_b16 a[70:71], v247 offset:10240
    v_mul_f32 v204, v221, v176
    v_mul_f32 v205, v221, v180
    v_mul_f32 v206, v221, v184
    v_mul_f32 v207, v221, v188
    s_mov_b32 s48, 0
    s_waitcnt lgkmcnt(0)
L_ct_33:
    buffer_load_dwordx4 v[24:27], v15, s[20:23], s55 offen sc1
    buffer_load_dwordx4 v[28:31], v15, s[20:23], s55 offen offset:256 sc1
    s_add_u32 s48, s48, 1
    s_cmp_gt_u32 s48, 131072
    s_cbranch_scc1 L_end
    s_waitcnt vmcnt(1)
    v_xor_b32 v3, s40, v24
    v_bitop3_b32 v3, v3, v25, s41 bitop3:0xf6
    v_bitop3_b32 v3, v3, v26, s42 bitop3:0xf6
    v_bitop3_b32 v3, v3, v27, s43 bitop3:0xf6
    s_waitcnt vmcnt(0)
    v_bitop3_b32 v3, v3, v28, s40 bitop3:0xf6
    v_bitop3_b32 v3, v3, v29, s41 bitop3:0xf6
    v_bitop3_b32 v3, v3, v30, s42 bitop3:0xf6
    v_bitop3_b32 v3, v3, v31, s43 bitop3:0xf6
    v_and_b32 v3, 0xff, v3
    v_cmp_ne_u32 vcc, 0, v3
    s_cbranch_vccnz L_ct_33
    v_add_f32_dpp v24, v24, v24 row_ror:4 row_mask:0xf bank_mask:0xf
    v_add_f32_dpp v25, v25, v25 row_ror:4 row_mask:0xf bank_mask:0xf
    v_add_f32_dpp v26, v26, v26 row_ror:4 row_mask:0xf bank_mask:0xf
    v_add_f32_dpp v27, v27, v27 row_ror:4 row_mask:0xf bank_mask:0xf
    v_add_f32_dpp v28, v28, v28 row_ror:4 row_mask:0xf bank_mask:0xf
    v_add_f32_dpp v29, v29, v29 row_ror:4 row_mask:0xf bank_mask:0xf
    v_add_f32_dpp v30, v30, v30 row_ror:4 row_mask:0xf bank_mask:0xf
    v_add_f32_dpp v31, v31, v31 row_ror:4 row_mask:0xf bank_mask:0xf
    v_add_f32_dpp v24, v24, v24 row_ror:8 row_mask:0xf bank_mask:0xf
    v_add_f32_dpp v25, v25, v25 row_ror:8 row_mask:0xf bank_mask:0xf
    v_add_f32_dpp v26, v26, v26 row_ror:8 row_mask:0xf bank_mask:0xf
    v_add_f32_dpp v27, v27, v27 row_ror:8 row_mask:0xf bank_mask:0xf
    v_add_f32_dpp v28, v28, v28 row_ror:8 row_mask:0xf bank_mask:0xf
    v_add_f32_dpp v29, v29, v29 row_ror:8 row_mask:0xf bank_mask:0xf
    v_add_f32_dpp v30, v30, v30 row_ror:8 row_mask:0xf bank_mask:0xf
    v_add_f32_dpp v31, v31, v31 row_ror:8 row_mask:0xf bank_mask:0xf
    v_cvt_pk_bf16_f32 v32, v24, v25
    v_cvt_pk_bf16_f32 v33, v26, v27
    v_cvt_pk_bf16_f32 v34, v28, v29
    v_cvt_pk_bf16_f32 v35, v30, v31
    v_cndmask_b32 v112, 0, v32, s[50:51]
    v_cndmask_b32 v113, 0, v33, s[50:51]
    v_cndmask_b32 v114, 0, v34, s[50:51]
    v_cndmask_b32 v115, 0, v35, s[50:51]
    v_cndmask_b32 v116, 0, v32, s[52:53]
    v_cndmask_b32 v117, 0, v33, s[52:53]
    v_mfma_f32_16x16x32_bf16 v[176:179], v[112:115], a[24:27], 0
    v_cndmask_b32 v118, 0, v34, s[52:53]
    v_mfma_f32_16x16x32_bf16 v[180:183], v[112:115], a[28:31], 0
    v_cndmask_b32 v119, 0, v35, s[52:53]
    v_mfma_f32_16x16x32_bf16 v[184:187], v[112:115], a[32:35], 0
    v_cndmask_b32 v120, 0, v32, s[58:59]
    v_mfma_f32_16x16x32_bf16 v[188:191], v[112:115], a[36:39], 0
    v_cndmask_b32 v121, 0, v33, s[58:59]
    v_mfma_f32_16x16x32_bf16 v[176:179], v[116:119], a[40:43], v[176:179]
    v_cndmask_b32 v122, 0, v34, s[58:59]
    v_mfma_f32_16x16x32_bf16 v[180:183], v[116:119], a[44:47], v[180:183]
    v_cndmask_b32 v123, 0, v35, s[58:59]
    v_mfma_f32_16x16x32_bf16 v[184:187], v[116:119], a[48:51], v[184:187]
    v_mfma_f32_16x16x32_bf16 v[188:191], v[116:119], a[52:55], v[188:191]
    v_mfma_f32_16x16x32_bf16 v[176:179], v[120:123], a[56:59], v[176:179]
    v_mfma_f32_16x16x32_bf16 v[180:183], v[120:123], a[60:63], v[180:183]
    v_mfma_f32_16x16x32_bf16 v[184:187], v[120:123], a[64:67], v[184:187]
    v_mfma_f32_16x16x32_bf16 v[188:191], v[120:123], a[68:71], v[188:191]
    s_nop 4
    v_pk_add_f32 v[176:177], v[176:177], v[178:179]
    v_pk_add_f32 v[180:181], v[180:181], v[182:183]
    v_pk_add_f32 v[184:185], v[184:185], v[186:187]
    v_pk_add_f32 v[188:189], v[188:189], v[190:191]
    v_add_f32 v24, v176, v177
    v_add_f32 v25, v180, v181
    v_add_f32 v26, v184, v185
    v_add_f32 v27, v188, v189
    v_fma_f32 v24, v24, v220, v204
    v_fma_f32 v25, v25, v220, v205
    v_fma_f32 v26, v26, v220, v206
    v_fma_f32 v27, v27, v220, v207
    v_bfi_b32 v24, v218, s40, v24
    v_bfi_b32 v25, v218, s41, v25
    v_bfi_b32 v26, v218, s42, v26
    v_bfi_b32 v27, v218, s43, v27
    s_mov_b32 exec_hi, s61
    buffer_store_dwordx4 v[24:27], v211, s[20:23], s4 offen sc1
L_fin:
L_end:
    s_endpgm
.section .rodata,"a"
.p2align 6
.amdhsa_kernel gated_mix__compressed_kv_cla__geglu_ffn__decode_kernel
  .amdhsa_next_free_vgpr 512
  .amdhsa_next_free_sgpr 102
  .amdhsa_accum_offset 256
  .amdhsa_group_segment_fixed_size 0
  .amdhsa_kernarg_size 112
  .amdhsa_user_sgpr_count 2
  .amdhsa_user_sgpr_kernarg_segment_ptr 1
  .amdhsa_system_sgpr_workgroup_id_x 1
  .amdhsa_float_denorm_mode_32 3
.end_amdhsa_kernel
```
